```python
import torch

def _softmax(x, axis=-1):
    return torch.softmax(x, dim=axis)
def _gelu(x):
    return torch.nn.functional.gelu(x, approximate="tanh")
def _silu(x):
    return torch.nn.functional.silu(x)
def _sigmoid(x):
    return torch.sigmoid(x)
def _layernorm(x, axis=-1, eps=1e-5):
    m = x.mean(dim=axis, keepdim=True)
    v = x.var(dim=axis, keepdim=True, unbiased=False)
    return (x - m) / torch.sqrt(v + eps)
def _scatter_add(tgt, idx, src, axis=0):
    return tgt.clone().index_add_(axis, idx, src)
def _segment_sum(src, seg, n):
    out = torch.zeros((n,) + src.shape[1:], dtype=src.dtype)
    return out.index_add_(0, seg, src)
def _pad(x, pw):
    flat = tuple(v for pair in reversed(pw) for v in pair)
    return torch.nn.functional.pad(x, flat)

kernel_name = 'concat_heads__sliding_block_cached__sliding_block_cached__decode'

def setup_inputs():

    _w = (lambda a: (lambda t: t.to(torch.bfloat16) if t.is_floating_point() else t)(torch.as_tensor(a)))
    def _A_setup():
        B, Sq, D = 1, 1, 640
        Hq, Hkv, Sk, Dh = 32, 32, 4096, 192
        assert Hq % Hkv == 0, (Hq, Hkv)
        return {
            "x": _w((lambda *s: torch.randn(*s, dtype=torch.bfloat16) * 1.6)(B, Sq, D)),
            "k_cache": _w((lambda *s: torch.randn(*s, dtype=torch.bfloat16) * 1.6)(B, Hkv, Sk, Dh)),
            "v_cache": _w((lambda *s: torch.randn(*s, dtype=torch.bfloat16) * 0.05)(B, Hkv, Sk, Dh)),
            "wq": _w((lambda *s: torch.randn(*s, dtype=torch.bfloat16) * 1.6)(D, Hq * Dh) * (D ** -0.5)),
            "wo": _w((lambda *s: torch.randn(*s, dtype=torch.bfloat16) * 0.05)(Hq * Dh, D) * ((Hq * Dh) ** -0.5)),
        }
    _A_in = _A_setup()

    def _B_setup():
        B, Sq, D = 1, 1, 640
        Hq, Hkv, Sk, Dh = 32, 32, 4096, 192
        assert Hq % Hkv == 0, (Hq, Hkv)
        return {
            "x": _w((lambda *s: torch.randn(*s, dtype=torch.bfloat16) * 1.6)(B, Sq, D)),
            "k_cache": _w((lambda *s: torch.randn(*s, dtype=torch.bfloat16) * 1.6)(B, Hkv, Sk, Dh)),
            "v_cache": _w((lambda *s: torch.randn(*s, dtype=torch.bfloat16) * 0.05)(B, Hkv, Sk, Dh)),
            "wq": _w((lambda *s: torch.randn(*s, dtype=torch.bfloat16) * 1.6)(D, Hq * Dh) * (D ** -0.5)),
            "wo": _w((lambda *s: torch.randn(*s, dtype=torch.bfloat16) * 0.05)(Hq * Dh, D) * ((Hq * Dh) ** -0.5)),
        }
    _B_in = _B_setup()

    return {
        "A_x": _A_in["x"],
        "A_k_cache": _A_in["k_cache"],
        "A_v_cache": _A_in["v_cache"],
        "A_wq": _A_in["wq"],
        "A_wo": _A_in["wo"],
        "B_x": _B_in["x"],
        "B_k_cache": _B_in["k_cache"],
        "B_v_cache": _B_in["v_cache"],
        "B_wq": _B_in["wq"],
        "B_wo": _B_in["wo"],
    }

def reference(A_x, A_k_cache, A_v_cache, A_wq, A_wo, B_x, B_k_cache, B_v_cache, B_wq, B_wo):
    def _A_ref(x, k_cache, v_cache, wq, wo):
        B, Sq, D = x.shape
        Hq, Dh = 32, 192
        Hkv, Sk = k_cache.shape[1], k_cache.shape[2]
        W = min(4096, max(256, Sk // 4))
        rep = Hq // Hkv
        q = (lambda x, *d: x.permute(*d))((x @ wq).reshape(B, Sq, Hq, Dh), 0, 2, 1, 3)
        k = (lambda x, n, axis: torch.repeat_interleave(x, n, dim=axis))(k_cache[:, :, Sk - W:, :], rep, axis=1)
        v = (lambda x, n, axis: torch.repeat_interleave(x, n, dim=axis))(v_cache[:, :, Sk - W:, :], rep, axis=1)
        scores = torch.einsum("bhqd,bhkd->bhqk", q, k) * (Dh ** -0.5)
        p = _softmax(scores, axis=-1)
        o = torch.einsum("bhqk,bhkd->bhqd", p, v)
        return (lambda x, *d: x.permute(*d))(o, 0, 2, 1, 3).reshape(B, Sq, Hq * Dh) @ wo

    def _B_ref(x, k_cache, v_cache, wq, wo):
        B, Sq, D = x.shape
        Hq, Dh = 32, 192
        Hkv, Sk = k_cache.shape[1], k_cache.shape[2]
        W = min(4096, max(256, Sk // 4))
        rep = Hq // Hkv
        q = (lambda x, *d: x.permute(*d))((x @ wq).reshape(B, Sq, Hq, Dh), 0, 2, 1, 3)
        k = (lambda x, n, axis: torch.repeat_interleave(x, n, dim=axis))(k_cache[:, :, Sk - W:, :], rep, axis=1)
        v = (lambda x, n, axis: torch.repeat_interleave(x, n, dim=axis))(v_cache[:, :, Sk - W:, :], rep, axis=1)
        scores = torch.einsum("bhqd,bhkd->bhqk", q, k) * (Dh ** -0.5)
        p = _softmax(scores, axis=-1)
        o = torch.einsum("bhqk,bhkd->bhqd", p, v)
        return (lambda x, *d: x.permute(*d))(o, 0, 2, 1, 3).reshape(B, Sq, Hq * Dh) @ wo

    a = _A_ref(A_x, A_k_cache, A_v_cache, A_wq, A_wo)
    b = _B_ref(B_x, B_k_cache, B_v_cache, B_wq, B_wo)
    return torch.concatenate([a, b], axis=-1)
```

```asm
; @launch grid=(256,1,1) block=(704,1,1) lds=163840
.amdgcn_target "amdgcn-amd-amdhsa--gfx950"
.text
.globl concat_heads__sliding_block_cached__sliding_block_cached__decode_kernel
.p2align 12
.type concat_heads__sliding_block_cached__sliding_block_cached__decode_kernel,@function
concat_heads__sliding_block_cached__sliding_block_cached__decode_kernel:
  s_cmp_ge_u32 s2, 256
  s_cbranch_scc1 L_done
  s_load_dwordx2 s[22:23], s[0:1], 96
  s_add_u32 s3, s2, 0
  s_and_b32 s3, s3, 7
  s_lshr_b32 s4, s2, 3
  s_and_b32 s5, s4, 3
  s_lshr_b32 s4, s4, 2
  s_lshl_b32 s3, s3, 3
  s_add_u32 s4, s4, s3
  s_lshr_b32 s6, s4, 5
  s_and_b32 s7, s4, 31
  s_lshl_b32 s9, s6, 7
  s_mul_i32 s8, s6, 40
  s_add_u32 s10, s0, s8
  s_addc_u32 s11, s1, 0
  s_load_dwordx8 s[12:19], s[10:11], 0
  s_load_dwordx2 s[20:21], s[10:11], 32
  v_lshrrev_b32 v1, 6, v0
  v_and_b32 v0, 63, v0
  v_readfirstlane_b32 s24, v1
  s_mov_b32 s26, 200000
  s_getreg_b32 s60, hwreg(HW_REG_XCC_ID, 0, 3)
  s_mov_b32 s40, 0x7060500
  s_mov_b32 s41, 0x7060501
  s_mov_b32 s42, 0x7060502
  s_mov_b32 s43, 0x7060503
  s_mov_b32 s44, 0x0c0c0400
  s_mov_b32 s45, 0x04000c0c
  s_cmp_lt_u32 s24, 3
  s_cbranch_scc1 L_w
  v_lshlrev_b32 v8, 2, v0
  v_mov_b32 v9, 0
  s_cmp_lg_u32 s24, 3
  s_cbranch_scc1 L_nz
  ds_write_b32 v8, v9
  s_branch L_pad1
L_nz:
  s_cmp_eq_u32 s24, 4
  s_cbranch_scc1 L_pad7
  s_cmp_eq_u32 s24, 5
  s_cbranch_scc1 L_pad8
  s_cmp_eq_u32 s24, 6
  s_cbranch_scc1 L_pad9
  s_cmp_eq_u32 s24, 7
  s_cbranch_scc1 L_pad0
  s_cmp_eq_u32 s24, 8
  s_cbranch_scc1 L_pad2
  s_cmp_eq_u32 s24, 9
  s_cbranch_scc1 L_pad3
  s_branch L_pad4
L_p1done:
  s_waitcnt lgkmcnt(0)
  s_load_dword s25, s[22:23], s9
  s_barrier
  s_cmp_eq_u32 s24, 3
  s_cbranch_scc1 L_pad16
  s_cmp_lt_u32 s24, 8
  s_cbranch_scc1 L_k
  s_cmp_eq_u32 s24, 8
  s_cbranch_scc1 L_pad5
  s_cmp_eq_u32 s24, 9
  s_cbranch_scc1 L_pad6
  s_branch L_pad10
L_pdone:
  s_cmp_eq_u32 s24, 3
  s_cbranch_scc1 L_aux
  s_branch L_v
L_w:
  s_setprio 3
  s_mov_b32 s27, s24
  s_mul_i32 s36, s5, 1966080
  s_mul_i32 s39, s7, 384
  s_add_u32 s36, s36, s39
  s_lshl_b32 s39, s27, 7
  s_add_u32 s36, s36, s39
  s_mul_i32 s38, s5, 320
  v_lshrrev_b32 v1, 3, v0
  v_mul_u32_u24 v1, 245760, v1
  v_and_b32 v8, 7, v0
  v_lshl_add_u32 v1, v8, 4, v1
  v_lshrrev_b32 v2, 4, v0
  v_and_b32 v8, 1, v0
  v_lshl_add_u32 v2, v2, 1, v8
  v_mul_u32_u24 v2, 40, v2
  s_lshr_b32 s62, s2, 4
  s_lshl_b32 s62, s62, 14
  s_and_b32 s63, s2, 15
  s_lshl_b32 s63, s63, 9
  s_add_u32 s62, s62, s63
  s_add_u32 s62, s62, 851968
  s_and_b32 s63, s5, 1
  s_lshl_b32 s63, s63, 13
  s_add_u32 s62, s62, s63
  s_xor_b32 s63, s62, 8192
  v_mov_b32 v165, 0
  s_mov_b32 s30, 0x10000000
  s_mov_b32 s31, 0x00020000
  s_cmp_lg_u32 s27, 0
  s_waitcnt lgkmcnt(0)
  s_mov_b32 s28, s22
  s_cbranch_scc1 L_wnp
  s_and_b32 s29, s23, 0xffff
  s_mov_b64 exec, 1
  buffer_load_dword v166, v165, s[28:31], s62 offen nt
  buffer_load_dword v167, v165, s[28:31], s63 offen nt
  s_mov_b64 exec, -1
L_wnp:
  s_load_dword s25, s[22:23], s9
  s_mov_b32 s32, s18
  s_and_b32 s33, s19, 0xffff
  s_mov_b32 s34, 7864320
  s_mov_b32 s35, 0x00020000
  s_mov_b32 s48, s12
  s_and_b32 s49, s13, 0xffff
  s_mov_b32 s50, 1280
  s_mov_b32 s51, 0x00020000
  buffer_load_dwordx4 v[24:27], v2, s[48:51], s38 offen offset:0
  buffer_load_dwordx4 v[28:31], v2, s[48:51], s38 offen offset:16
  buffer_load_dwordx2 v[32:33], v2, s[48:51], s38 offen offset:32
  buffer_load_dwordx4 v[40:43], v1, s[32:35], s36 offen nt
  s_add_u32 s36, s36, 12288
  buffer_load_dwordx4 v[44:47], v1, s[32:35], s36 offen nt
  s_add_u32 s36, s36, 12288
  buffer_load_dwordx4 v[48:51], v1, s[32:35], s36 offen nt
  s_add_u32 s36, s36, 12288
  buffer_load_dwordx4 v[52:55], v1, s[32:35], s36 offen nt
  s_add_u32 s36, s36, 12288
  buffer_load_dwordx4 v[56:59], v1, s[32:35], s36 offen nt
  s_add_u32 s36, s36, 12288
  buffer_load_dwordx4 v[60:63], v1, s[32:35], s36 offen nt
  s_add_u32 s36, s36, 12288
  buffer_load_dwordx4 v[64:67], v1, s[32:35], s36 offen nt
  s_add_u32 s36, s36, 12288
  buffer_load_dwordx4 v[68:71], v1, s[32:35], s36 offen nt
  s_add_u32 s36, s36, 12288
  s_mov_b32 s28, s22
  s_and_b32 s29, s23, 0xffff
  s_mov_b32 s30, 268435456
  s_mov_b32 s31, 0x00020000
  v_bfe_u32 v8, v0, 2, 2
  v_bfe_u32 v9, v0, 1, 1
  v_cmp_eq_u32 vcc, 1, v9
  v_mov_b32 v10, 0x0c0c0100
  v_mov_b32 v11, 0x01000c0c
  v_cndmask_b32 v10, v10, v11, vcc
  v_mov_b32 v9, 0x0c0c0302
  v_mov_b32 v11, 0x03020c0c
  v_cndmask_b32 v11, v9, v11, vcc
  v_mov_b32 v9, 0x0c0c0c0c
  v_cmp_eq_u32 vcc, 0, v8
  s_nop 1
  v_cndmask_b32 v16, v9, v10, vcc
  v_cndmask_b32 v17, v9, v11, vcc
  v_cmp_eq_u32 vcc, 1, v8
  s_nop 1
  v_cndmask_b32 v18, v9, v10, vcc
  v_cndmask_b32 v19, v9, v11, vcc
  v_cmp_eq_u32 vcc, 2, v8
  s_nop 1
  v_cndmask_b32 v20, v9, v10, vcc
  v_cndmask_b32 v21, v9, v11, vcc
  v_cmp_eq_u32 vcc, 3, v8
  s_nop 1
  v_cndmask_b32 v22, v9, v10, vcc
  v_cndmask_b32 v23, v9, v11, vcc
  s_cmp_lg_u32 s27, 0
  s_cbranch_scc1 L_wnq
  s_waitcnt vmcnt(12)
  s_nop 3
  s_getreg_b32 s63, hwreg(HW_REG_IB_STS, 0, 4)
  s_bitcmp1_b32 s5, 0
  s_cselect_b32 s62, 0, 16
  s_cmp_eq_u32 s63, 12
  s_cselect_b32 s62, s62, 32
L_wnq:
  s_waitcnt lgkmcnt(0)
  s_mul_i32 s25, s25, 0x9E3779B1
  s_add_u32 s25, s25, 0x7F4A7C15
  s_andn2_b32 s25, s25, 15
  s_or_b32 s25, s25, 8
  s_or_b32 s25, s25, s60
  v_mov_b32 v3, s25
  s_waitcnt vmcnt(8)
  s_lshl_b32 s37, s27, 2
  v_mov_b32 v2, s37
  v_perm_b32 v8, v24, v24, v16
  v_perm_b32 v9, v24, v24, v18
  v_perm_b32 v10, v24, v24, v20
  v_perm_b32 v11, v24, v24, v22
  v_perm_b32 v12, v24, v24, v17
  v_perm_b32 v13, v24, v24, v19
  s_branch L_pad0_x
L_pad0:
  s_branch L_p1done
L_pad0_x:
  v_perm_b32 v14, v24, v24, v21
  v_perm_b32 v15, v24, v24, v23
  s_waitcnt vmcnt(7)
  buffer_load_dwordx4 v[72:75], v1, s[32:35], s36 offen nt
  s_add_u32 s36, s36, 12288
  v_mfma_f32_16x16x32_bf16 v[4:7], v[8:11], v[40:43], 0
  v_perm_b32 v8, v25, v25, v16
  v_perm_b32 v9, v25, v25, v18
  v_perm_b32 v10, v25, v25, v20
  v_perm_b32 v11, v25, v25, v22
  s_waitcnt vmcnt(7)
  s_barrier
  buffer_load_dwordx4 v[76:79], v1, s[32:35], s36 offen nt
  s_add_u32 s36, s36, 12288
  v_mfma_f32_16x16x32_bf16 v[4:7], v[12:15], v[44:47], v[4:7]
  v_perm_b32 v12, v25, v25, v17
  v_perm_b32 v13, v25, v25, v19
  v_perm_b32 v14, v25, v25, v21
  v_perm_b32 v15, v25, v25, v23
  s_waitcnt vmcnt(7)
  buffer_load_dwordx4 v[80:83], v1, s[32:35], s36 offen nt
  s_add_u32 s36, s36, 12288
  v_mfma_f32_16x16x32_bf16 v[4:7], v[8:11], v[48:51], v[4:7]
  v_perm_b32 v8, v26, v26, v16
  v_perm_b32 v9, v26, v26, v18
  v_perm_b32 v10, v26, v26, v20
  v_perm_b32 v11, v26, v26, v22
  s_waitcnt vmcnt(7)
  buffer_load_dwordx4 v[84:87], v1, s[32:35], s36 offen nt
  s_add_u32 s36, s36, 12288
  v_mfma_f32_16x16x32_bf16 v[4:7], v[12:15], v[52:55], v[4:7]
  v_perm_b32 v12, v26, v26, v17
  v_perm_b32 v13, v26, v26, v19
  v_perm_b32 v14, v26, v26, v21
  v_perm_b32 v15, v26, v26, v23
  s_waitcnt vmcnt(7)
  buffer_load_dwordx4 v[88:91], v1, s[32:35], s36 offen nt
  s_add_u32 s36, s36, 12288
  v_mfma_f32_16x16x32_bf16 v[4:7], v[8:11], v[56:59], v[4:7]
  v_perm_b32 v8, v27, v27, v16
  v_perm_b32 v9, v27, v27, v18
  v_perm_b32 v10, v27, v27, v20
  v_perm_b32 v11, v27, v27, v22
  s_waitcnt vmcnt(7)
  buffer_load_dwordx4 v[92:95], v1, s[32:35], s36 offen nt
  s_add_u32 s36, s36, 12288
  v_mfma_f32_16x16x32_bf16 v[4:7], v[12:15], v[60:63], v[4:7]
  v_perm_b32 v12, v27, v27, v17
  v_perm_b32 v13, v27, v27, v19
  v_perm_b32 v14, v27, v27, v21
  v_perm_b32 v15, v27, v27, v23
  s_waitcnt vmcnt(7)
  buffer_load_dwordx4 v[96:99], v1, s[32:35], s36 offen nt
  s_add_u32 s36, s36, 12288
  v_mfma_f32_16x16x32_bf16 v[4:7], v[8:11], v[64:67], v[4:7]
  v_perm_b32 v8, v28, v28, v16
  v_perm_b32 v9, v28, v28, v18
  v_perm_b32 v10, v28, v28, v20
  v_perm_b32 v11, v28, v28, v22
  s_waitcnt vmcnt(7)
  buffer_load_dwordx4 v[100:103], v1, s[32:35], s36 offen nt
  s_add_u32 s36, s36, 12288
  v_mfma_f32_16x16x32_bf16 v[4:7], v[12:15], v[68:71], v[4:7]
  v_perm_b32 v12, v28, v28, v17
  v_perm_b32 v13, v28, v28, v19
  v_perm_b32 v14, v28, v28, v21
  v_perm_b32 v15, v28, v28, v23
  s_waitcnt vmcnt(7)
  buffer_load_dwordx4 v[104:107], v1, s[32:35], s36 offen nt
  s_add_u32 s36, s36, 12288
  v_mfma_f32_16x16x32_bf16 v[4:7], v[8:11], v[72:75], v[4:7]
  v_perm_b32 v8, v29, v29, v16
  v_perm_b32 v9, v29, v29, v18
  v_perm_b32 v10, v29, v29, v20
  v_perm_b32 v11, v29, v29, v22
  s_waitcnt vmcnt(7)
  buffer_load_dwordx4 v[108:111], v1, s[32:35], s36 offen nt
  s_add_u32 s36, s36, 12288
  v_mfma_f32_16x16x32_bf16 v[4:7], v[12:15], v[76:79], v[4:7]
  v_perm_b32 v12, v29, v29, v17
  v_perm_b32 v13, v29, v29, v19
  v_perm_b32 v14, v29, v29, v21
  v_perm_b32 v15, v29, v29, v23
  s_waitcnt vmcnt(7)
  buffer_load_dwordx4 v[112:115], v1, s[32:35], s36 offen nt
  s_add_u32 s36, s36, 12288
  v_mfma_f32_16x16x32_bf16 v[4:7], v[8:11], v[80:83], v[4:7]
  v_perm_b32 v8, v30, v30, v16
  v_perm_b32 v9, v30, v30, v18
  v_perm_b32 v10, v30, v30, v20
  v_perm_b32 v11, v30, v30, v22
  s_waitcnt vmcnt(7)
  buffer_load_dwordx4 v[116:119], v1, s[32:35], s36 offen nt
  v_mfma_f32_16x16x32_bf16 v[4:7], v[12:15], v[84:87], v[4:7]
  v_perm_b32 v12, v30, v30, v17
  v_perm_b32 v13, v30, v30, v19
  v_perm_b32 v14, v30, v30, v21
  v_perm_b32 v15, v30, v30, v23
  s_waitcnt vmcnt(7)
  v_mov_b32 v164, 1
  ds_write_b32 v2, v164 offset:0
  v_mfma_f32_16x16x32_bf16 v[4:7], v[8:11], v[88:91], v[4:7]
  v_perm_b32 v8, v31, v31, v16
  v_perm_b32 v9, v31, v31, v18
  v_perm_b32 v10, v31, v31, v20
  v_perm_b32 v11, v31, v31, v22
  s_waitcnt vmcnt(6)
  v_mov_b32 v164, 2
  ds_write_b32 v2, v164 offset:0
  v_mfma_f32_16x16x32_bf16 v[4:7], v[12:15], v[92:95], v[4:7]
  v_perm_b32 v12, v31, v31, v17
  v_perm_b32 v13, v31, v31, v19
  v_perm_b32 v14, v31, v31, v21
  v_perm_b32 v15, v31, v31, v23
  s_waitcnt vmcnt(5)
  v_mov_b32 v164, 3
  ds_write_b32 v2, v164 offset:0
  v_mfma_f32_16x16x32_bf16 v[4:7], v[8:11], v[96:99], v[4:7]
  v_perm_b32 v8, v32, v32, v16
  v_perm_b32 v9, v32, v32, v18
  v_perm_b32 v10, v32, v32, v20
  v_perm_b32 v11, v32, v32, v22
  s_waitcnt vmcnt(4)
  v_mov_b32 v164, 4
  ds_write_b32 v2, v164 offset:0
  v_mfma_f32_16x16x32_bf16 v[4:7], v[12:15], v[100:103], v[4:7]
  v_perm_b32 v12, v32, v32, v17
  v_perm_b32 v13, v32, v32, v19
  v_perm_b32 v14, v32, v32, v21
  v_perm_b32 v15, v32, v32, v23
  s_waitcnt vmcnt(3)
  v_mov_b32 v164, 5
  ds_write_b32 v2, v164 offset:0
  v_mfma_f32_16x16x32_bf16 v[4:7], v[8:11], v[104:107], v[4:7]
  v_perm_b32 v8, v33, v33, v16
  v_perm_b32 v9, v33, v33, v18
  v_perm_b32 v10, v33, v33, v20
  v_perm_b32 v11, v33, v33, v22
  s_branch L_pad1_x
L_pad1:
  s_branch L_p1done
L_pad1_x:
  s_waitcnt vmcnt(2)
  v_mov_b32 v164, 6
  ds_write_b32 v2, v164 offset:0
  v_mfma_f32_16x16x32_bf16 v[4:7], v[12:15], v[108:111], v[4:7]
  v_perm_b32 v12, v33, v33, v17
  v_perm_b32 v13, v33, v33, v19
  v_perm_b32 v14, v33, v33, v21
  v_perm_b32 v15, v33, v33, v23
  s_waitcnt vmcnt(1)
  v_mov_b32 v164, 7
  ds_write_b32 v2, v164 offset:0
  v_mfma_f32_16x16x32_bf16 v[4:7], v[8:11], v[112:115], v[4:7]
  s_nop 1
  s_waitcnt vmcnt(0)
  v_mov_b32 v164, 8
  ds_write_b32 v2, v164 offset:0
  v_mfma_f32_16x16x32_bf16 v[4:7], v[12:15], v[116:119], v[4:7]
  s_nop 7
  v_add_f32_dpp v40, v5, v4 row_ror:8 row_mask:0xf bank_mask:0xf
  v_add_f32_dpp v41, v7, v6 row_ror:8 row_mask:0xf bank_mask:0xf
  v_mov_b32 v42, 0
  v_mov_b32 v43, 0
  s_nop 1
  v_permlane16_swap_b32 v40, v42
  v_permlane16_swap_b32 v41, v43
  s_nop 1
  v_perm_b32 v40, v40, v3, s40
  v_perm_b32 v41, v41, v3, s41
  v_perm_b32 v42, v42, v3, s42
  v_perm_b32 v43, v43, v3, s43
  v_and_b32 v48, 7, v0
  v_lshrrev_b32 v49, 5, v0
  v_lshl_add_u32 v48, v48, 1, v49
  v_lshlrev_b32 v48, 4, v48
  s_mul_i32 s36, s4, 3072
  s_lshl_b32 s37, s27, 10
  s_add_u32 s36, s36, s37
  s_add_u32 s36, s36, 65536
  s_lshl_b32 s39, s5, 8
  s_add_u32 s39, s39, s36
  s_mov_b32 exec_lo, 0xff
  s_mov_b32 exec_hi, 0xff
  buffer_store_dwordx4 v[40:43], v48, s[28:31], s39 offen
  s_mov_b64 exec, -1
  v_and_b32 v50, 3, v0
  v_lshrrev_b32 v51, 2, v0
  v_lshlrev_b32 v52, 4, v51
  v_lshl_add_u32 v52, v50, 8, v52
  buffer_load_dwordx4 v[144:147], v52, s[28:31], s36 offen sc1 nt
  s_sleep 10
  buffer_load_dwordx4 v[148:151], v52, s[28:31], s36 offen sc1 nt
  s_sleep 10
  s_mov_b32 s59, 0
Lp_1:
  buffer_load_dwordx4 v[152:155], v52, s[28:31], s36 offen sc1 nt
  s_waitcnt vmcnt(2)
  v_perm_b32 v140, v145, v144, s44
  v_perm_b32 v141, v147, v146, s45
  v_or_b32 v140, v140, v141
  v_xor_b32 v140, s25, v140
  v_cmp_lt_u32 vcc, 7, v140
  s_cmp_eq_u64 vcc, 0
  s_cbranch_scc1 Lpf_3
  buffer_load_dwordx4 v[144:147], v52, s[28:31], s36 offen sc1 nt
  s_waitcnt vmcnt(2)
  v_perm_b32 v140, v149, v148, s44
  v_perm_b32 v141, v151, v150, s45
  v_or_b32 v140, v140, v141
  v_xor_b32 v140, s25, v140
  v_cmp_lt_u32 vcc, 7, v140
  s_cmp_eq_u64 vcc, 0
  s_cbranch_scc1 Lpf_4
  buffer_load_dwordx4 v[148:151], v52, s[28:31], s36 offen sc1 nt
  s_waitcnt vmcnt(2)
  v_perm_b32 v140, v153, v152, s44
  v_perm_b32 v141, v155, v154, s45
  v_or_b32 v140, v140, v141
  v_xor_b32 v140, s25, v140
  v_cmp_lt_u32 vcc, 7, v140
  s_cmp_eq_u64 vcc, 0
  s_cbranch_scc1 Lpf_5
  s_add_u32 s59, s59, 1
  s_cmp_lg_u32 s59, 6
  s_cbranch_scc1 Lp_1_t
  s_mov_b32 exec_lo, 0xff
  s_mov_b32 exec_hi, 0xff
  buffer_store_dwordx4 v[40:43], v48, s[28:31], s39 offen sc1
  s_mov_b64 exec, -1
Lp_1_t:
  s_sub_u32 s26, s26, 1
  s_cbranch_scc0 Lp_1
  s_branch L_end
Lpf_3:
  v_mov_b32 v136, v144
  v_mov_b32 v137, v145
  v_mov_b32 v138, v146
  v_mov_b32 v139, v147
  s_branch Lpd_2
Lpf_4:
  v_mov_b32 v136, v148
  v_mov_b32 v137, v149
  v_mov_b32 v138, v150
  v_mov_b32 v139, v151
  s_branch Lpd_2
Lpf_5:
  v_mov_b32 v136, v152
  v_mov_b32 v137, v153
  v_mov_b32 v138, v154
  v_mov_b32 v139, v155
Lpd_2:
  s_nop 1
  v_cmp_ne_u32 vcc, 0, v140
  s_cmp_lg_u64 vcc, 0
  s_cselect_b32 s58, 1, 0
  v_mov_b32 v53, s58
  v_mov_b32 v54, 0
  s_cbranch_scc0 Ls_6
  s_mov_b32 exec_lo, 0xff
  s_mov_b32 exec_hi, 0xff
  buffer_store_dwordx4 v[40:43], v48, s[28:31], s39 offen sc1
  s_mov_b64 exec, -1
Ls_6:
  v_add_f32_dpp v140, v136, v136 quad_perm:[1,0,3,2] row_mask:0xf bank_mask:0xf
  v_add_f32_dpp v141, v137, v137 quad_perm:[1,0,3,2] row_mask:0xf bank_mask:0xf
  v_add_f32_dpp v142, v138, v138 quad_perm:[1,0,3,2] row_mask:0xf bank_mask:0xf
  v_add_f32_dpp v143, v139, v139 quad_perm:[1,0,3,2] row_mask:0xf bank_mask:0xf
  v_add_f32_dpp v136, v140, v140 quad_perm:[2,3,0,1] row_mask:0xf bank_mask:0xf
  v_add_f32_dpp v137, v141, v141 quad_perm:[2,3,0,1] row_mask:0xf bank_mask:0xf
  v_add_f32_dpp v138, v142, v142 quad_perm:[2,3,0,1] row_mask:0xf bank_mask:0xf
  v_add_f32_dpp v139, v143, v143 quad_perm:[2,3,0,1] row_mask:0xf bank_mask:0xf
  v_cvt_pk_bf16_f32 v140, v136, v137
  v_cvt_pk_bf16_f32 v141, v138, v139
  s_lshl_b32 s37, s27, 7
  v_lshlrev_b32 v51, 3, v51
  v_add_u32 v51, s37, v51
  s_lshl_b32 s37, s27, 2
  v_mov_b32 v50, s37
  s_mov_b32 exec_lo, 0x11111111
  s_mov_b32 exec_hi, 0x11111111
  ds_write_b64 v51, v[140:141] offset:256
  ds_write_b32 v54, v53 offset:148
  ds_write_b32 v50, v3 offset:48
  s_mov_b64 exec, -1
  s_cmp_lg_u32 s27, 0
  s_cbranch_scc1 L_wnv
  s_xor_b32 s62, s62, s25
  v_mov_b32 v166, s62
  s_lshl_b32 s63, s60, 10
  s_add_u32 s63, s63, 499712
  s_lshl_b32 s37, s2, 2
  v_mov_b32 v165, s37
  s_mov_b64 exec, 1
  buffer_store_dword v166, v165, s[28:31], s63 offen
  s_mov_b64 exec, -1
L_wnv:
L_wo:
  s_lshl_b32 s37, s27, 2
  v_mov_b32 v161, s37
  s_and_b32 s37, s5, 1
  s_add_u32 s37, s37, s27
  s_cmp_eq_u32 s37, 3
  s_cbranch_scc1 L_w_fin
  s_setprio 0
  s_mov_b32 s32, s20
  s_and_b32 s33, s21, 0xffff
  s_mov_b32 s34, 7864320
  s_mov_b32 s35, 0x00020000
  v_lshrrev_b32 v1, 3, v0
  v_mul_u32_u24 v1, 30720, v1
  v_and_b32 v8, 7, v0
  v_lshl_add_u32 v1, v8, 4, v1
  s_mul_i32 s37, s5, 5
  s_add_u32 s37, s37, 1
  s_lshr_b32 s37, s37, 1
  s_add_u32 s52, s37, s27
  s_mul_i32 s36, s7, 245760
  s_lshl_b32 s37, s52, 7
  s_add_u32 s36, s36, s37
  s_add_u32 s56, s27, 1
  s_mul_i32 s56, s56, 24
  s_mov_b32 s57, 0
  v_mov_b32 v24, 0
  s_bitcmp1_b32 s5, 0
  s_cbranch_scc0 L_wo_e
Lg_31:
  s_cmp_ge_u32 s57, s56
  s_cbranch_scc1 Lgo_32
  ds_read_b128 v[28:31], v24 offset:32
  s_waitcnt lgkmcnt(0)
  v_add3_u32 v28, v28, v29, v30
  v_add_u32 v28, v28, v31
  s_nop 0
  v_readfirstlane_b32 s57, v28
  s_mul_i32 s57, s57, 14
  s_cmp_ge_u32 s57, s56
  s_cbranch_scc1 Lgo_32
  s_sleep 1
  s_sub_u32 s26, s26, 1
  s_cbranch_scc0 Lg_31
  s_branch L_end
L_pad2:
  s_branch L_p1done
Lgo_32:
  s_add_u32 s56, s56, 48
  buffer_load_dwordx4 v[40:43], v1, s[32:35], s36 offen nt
  s_add_u32 s36, s36, 1280
Lg_33:
  s_cmp_ge_u32 s57, s56
  s_cbranch_scc1 Lgo_34
  ds_read_b128 v[28:31], v24 offset:32
  s_waitcnt lgkmcnt(0)
  v_add3_u32 v28, v28, v29, v30
  v_add_u32 v28, v28, v31
  s_nop 0
  v_readfirstlane_b32 s57, v28
  s_mul_i32 s57, s57, 14
  s_cmp_ge_u32 s57, s56
  s_cbranch_scc1 Lgo_34
  s_sleep 1
  s_sub_u32 s26, s26, 1
  s_cbranch_scc0 Lg_33
  s_branch L_end
Lgo_34:
  s_add_u32 s56, s56, 48
  buffer_load_dwordx4 v[44:47], v1, s[32:35], s36 offen nt
  s_add_u32 s36, s36, 1280
Lg_35:
  s_cmp_ge_u32 s57, s56
  s_cbranch_scc1 Lgo_36
  ds_read_b128 v[28:31], v24 offset:32
  s_waitcnt lgkmcnt(0)
  v_add3_u32 v28, v28, v29, v30
  v_add_u32 v28, v28, v31
  s_nop 0
  v_readfirstlane_b32 s57, v28
  s_mul_i32 s57, s57, 14
  s_cmp_ge_u32 s57, s56
  s_cbranch_scc1 Lgo_36
  s_sleep 1
  s_sub_u32 s26, s26, 1
  s_cbranch_scc0 Lg_35
  s_branch L_end
Lgo_36:
  s_add_u32 s56, s56, 48
  buffer_load_dwordx4 v[48:51], v1, s[32:35], s36 offen nt
  s_add_u32 s36, s36, 1280
Lg_37:
  s_cmp_ge_u32 s57, s56
  s_cbranch_scc1 Lgo_38
  ds_read_b128 v[28:31], v24 offset:32
  s_waitcnt lgkmcnt(0)
  v_add3_u32 v28, v28, v29, v30
  v_add_u32 v28, v28, v31
  s_nop 0
  v_readfirstlane_b32 s57, v28
  s_mul_i32 s57, s57, 14
  s_cmp_ge_u32 s57, s56
  s_cbranch_scc1 Lgo_38
  s_sleep 1
  s_sub_u32 s26, s26, 1
  s_cbranch_scc0 Lg_37
  s_branch L_end
Lgo_38:
  s_add_u32 s56, s56, 48
  buffer_load_dwordx4 v[52:55], v1, s[32:35], s36 offen nt
  s_add_u32 s36, s36, 1280
Lg_39:
  s_cmp_ge_u32 s57, s56
  s_cbranch_scc1 Lgo_40
  ds_read_b128 v[28:31], v24 offset:32
  s_waitcnt lgkmcnt(0)
  v_add3_u32 v28, v28, v29, v30
  v_add_u32 v28, v28, v31
  s_nop 0
  v_readfirstlane_b32 s57, v28
  s_mul_i32 s57, s57, 14
  s_cmp_ge_u32 s57, s56
  s_cbranch_scc1 Lgo_40
  s_sleep 1
  s_sub_u32 s26, s26, 1
  s_cbranch_scc0 Lg_39
  s_branch L_end
Lgo_40:
  s_add_u32 s56, s56, 48
  buffer_load_dwordx4 v[56:59], v1, s[32:35], s36 offen nt
  s_add_u32 s36, s36, 1280
Lg_41:
  s_cmp_ge_u32 s57, s56
  s_cbranch_scc1 Lgo_42
  ds_read_b128 v[28:31], v24 offset:32
  s_waitcnt lgkmcnt(0)
  v_add3_u32 v28, v28, v29, v30
  v_add_u32 v28, v28, v31
  s_nop 0
  v_readfirstlane_b32 s57, v28
  s_mul_i32 s57, s57, 14
  s_cmp_ge_u32 s57, s56
  s_cbranch_scc1 Lgo_42
  s_sleep 1
  s_sub_u32 s26, s26, 1
  s_cbranch_scc0 Lg_41
  s_branch L_end
Lgo_42:
  s_add_u32 s56, s56, 48
  buffer_load_dwordx4 v[60:63], v1, s[32:35], s36 offen nt
  s_add_u32 s36, s36, 1280
Lg_43:
  s_cmp_ge_u32 s57, s56
  s_cbranch_scc1 Lgo_44
  ds_read_b128 v[28:31], v24 offset:32
  s_waitcnt lgkmcnt(0)
  v_add3_u32 v28, v28, v29, v30
  v_add_u32 v28, v28, v31
  s_nop 0
  v_readfirstlane_b32 s57, v28
  s_mul_i32 s57, s57, 14
  s_cmp_ge_u32 s57, s56
  s_cbranch_scc1 Lgo_44
  s_sleep 1
  s_sub_u32 s26, s26, 1
  s_cbranch_scc0 Lg_43
  s_branch L_end
Lgo_44:
  s_add_u32 s56, s56, 48
  buffer_load_dwordx4 v[64:67], v1, s[32:35], s36 offen nt
  s_add_u32 s36, s36, 1280
  ds_read_b128 v[28:31], v24 offset:160
  s_waitcnt lgkmcnt(0)
  v_and_b32 v28, v28, v29
  v_and_or_b32 v28, v28, v30, v31
  v_cmp_ne_u32 vcc, 0, v28
  s_cbranch_vccnz Lb_14
  s_waitcnt vmcnt(6)
  buffer_load_dwordx4 v[68:71], v1, s[32:35], s36 offen nt
  s_add_u32 s36, s36, 1280
  ds_read_b128 v[28:31], v24 offset:160
  s_waitcnt lgkmcnt(0)
  v_and_b32 v28, v28, v29
  v_and_or_b32 v28, v28, v30, v31
  v_cmp_ne_u32 vcc, 0, v28
  s_cbranch_vccnz Lb_15
  s_waitcnt vmcnt(6)
  buffer_load_dwordx4 v[72:75], v1, s[32:35], s36 offen nt
  s_add_u32 s36, s36, 1280
  ds_read_b128 v[28:31], v24 offset:160
  s_waitcnt lgkmcnt(0)
  v_and_b32 v28, v28, v29
  v_and_or_b32 v28, v28, v30, v31
  v_cmp_ne_u32 vcc, 0, v28
  s_cbranch_vccnz Lb_16
  s_waitcnt vmcnt(6)
  buffer_load_dwordx4 v[76:79], v1, s[32:35], s36 offen nt
  s_add_u32 s36, s36, 1280
  ds_read_b128 v[28:31], v24 offset:160
  s_waitcnt lgkmcnt(0)
  v_and_b32 v28, v28, v29
  v_and_or_b32 v28, v28, v30, v31
  v_cmp_ne_u32 vcc, 0, v28
  s_cbranch_vccnz Lb_17
  s_waitcnt vmcnt(6)
  buffer_load_dwordx4 v[80:83], v1, s[32:35], s36 offen nt
  s_add_u32 s36, s36, 1280
  ds_read_b128 v[28:31], v24 offset:160
  s_waitcnt lgkmcnt(0)
  v_and_b32 v28, v28, v29
  v_and_or_b32 v28, v28, v30, v31
  v_cmp_ne_u32 vcc, 0, v28
  s_cbranch_vccnz Lb_18
  s_waitcnt vmcnt(6)
  buffer_load_dwordx4 v[84:87], v1, s[32:35], s36 offen nt
  s_add_u32 s36, s36, 1280
  ds_read_b128 v[28:31], v24 offset:160
  s_waitcnt lgkmcnt(0)
  v_and_b32 v28, v28, v29
  v_and_or_b32 v28, v28, v30, v31
  v_cmp_ne_u32 vcc, 0, v28
  s_cbranch_vccnz Lb_19
  s_waitcnt vmcnt(6)
  buffer_load_dwordx4 v[88:91], v1, s[32:35], s36 offen nt
  s_add_u32 s36, s36, 1280
  ds_read_b128 v[28:31], v24 offset:160
  s_waitcnt lgkmcnt(0)
  v_and_b32 v28, v28, v29
  v_and_or_b32 v28, v28, v30, v31
  v_cmp_ne_u32 vcc, 0, v28
  s_cbranch_vccnz Lb_20
  s_waitcnt vmcnt(6)
  buffer_load_dwordx4 v[92:95], v1, s[32:35], s36 offen nt
  s_add_u32 s36, s36, 1280
  ds_read_b128 v[28:31], v24 offset:160
  s_waitcnt lgkmcnt(0)
  v_and_b32 v28, v28, v29
  v_and_or_b32 v28, v28, v30, v31
  v_cmp_ne_u32 vcc, 0, v28
  s_cbranch_vccnz Lb_21
  s_waitcnt vmcnt(6)
  buffer_load_dwordx4 v[96:99], v1, s[32:35], s36 offen nt
  s_add_u32 s36, s36, 1280
  ds_read_b128 v[28:31], v24 offset:160
  s_waitcnt lgkmcnt(0)
  v_and_b32 v28, v28, v29
  v_and_or_b32 v28, v28, v30, v31
  v_cmp_ne_u32 vcc, 0, v28
  s_cbranch_vccnz Lb_22
  s_waitcnt vmcnt(6)
  buffer_load_dwordx4 v[100:103], v1, s[32:35], s36 offen nt
  s_add_u32 s36, s36, 1280
  s_branch L_pad3_x
L_pad3:
  s_branch L_p1done
L_pad3_x:
  ds_read_b128 v[28:31], v24 offset:160
  s_waitcnt lgkmcnt(0)
  v_and_b32 v28, v28, v29
  v_and_or_b32 v28, v28, v30, v31
  v_cmp_ne_u32 vcc, 0, v28
  s_cbranch_vccnz Lb_23
  s_waitcnt vmcnt(6)
  buffer_load_dwordx4 v[104:107], v1, s[32:35], s36 offen nt
  s_add_u32 s36, s36, 1280
  ds_read_b128 v[28:31], v24 offset:160
  s_waitcnt lgkmcnt(0)
  v_and_b32 v28, v28, v29
  v_and_or_b32 v28, v28, v30, v31
  v_cmp_ne_u32 vcc, 0, v28
  s_cbranch_vccnz Lb_24
  s_waitcnt vmcnt(6)
  buffer_load_dwordx4 v[108:111], v1, s[32:35], s36 offen nt
  s_add_u32 s36, s36, 1280
  ds_read_b128 v[28:31], v24 offset:160
  s_waitcnt lgkmcnt(0)
  v_and_b32 v28, v28, v29
  v_and_or_b32 v28, v28, v30, v31
  v_cmp_ne_u32 vcc, 0, v28
  s_cbranch_vccnz Lb_25
  s_waitcnt vmcnt(6)
  buffer_load_dwordx4 v[112:115], v1, s[32:35], s36 offen nt
  s_add_u32 s36, s36, 1280
  ds_read_b128 v[28:31], v24 offset:160
  s_waitcnt lgkmcnt(0)
  v_and_b32 v28, v28, v29
  v_and_or_b32 v28, v28, v30, v31
  v_cmp_ne_u32 vcc, 0, v28
  s_cbranch_vccnz Lb_26
  s_waitcnt vmcnt(6)
  buffer_load_dwordx4 v[116:119], v1, s[32:35], s36 offen nt
  s_add_u32 s36, s36, 1280
  ds_read_b128 v[28:31], v24 offset:160
  s_waitcnt lgkmcnt(0)
  v_and_b32 v28, v28, v29
  v_and_or_b32 v28, v28, v30, v31
  v_cmp_ne_u32 vcc, 0, v28
  s_cbranch_vccnz Lb_27
  s_waitcnt vmcnt(6)
  buffer_load_dwordx4 v[120:123], v1, s[32:35], s36 offen nt
  s_add_u32 s36, s36, 1280
  ds_read_b128 v[28:31], v24 offset:160
  s_waitcnt lgkmcnt(0)
  v_and_b32 v28, v28, v29
  v_and_or_b32 v28, v28, v30, v31
  v_cmp_ne_u32 vcc, 0, v28
  s_cbranch_vccnz Lb_28
  s_waitcnt vmcnt(6)
  buffer_load_dwordx4 v[124:127], v1, s[32:35], s36 offen nt
  s_add_u32 s36, s36, 1280
  ds_read_b128 v[28:31], v24 offset:160
  s_waitcnt lgkmcnt(0)
  v_and_b32 v28, v28, v29
  v_and_or_b32 v28, v28, v30, v31
  v_cmp_ne_u32 vcc, 0, v28
  s_cbranch_vccnz Lb_29
  s_waitcnt vmcnt(6)
  buffer_load_dwordx4 v[128:131], v1, s[32:35], s36 offen nt
  s_add_u32 s36, s36, 1280
  ds_read_b128 v[28:31], v24 offset:160
  s_waitcnt lgkmcnt(0)
  v_and_b32 v28, v28, v29
  v_and_or_b32 v28, v28, v30, v31
  v_cmp_ne_u32 vcc, 0, v28
  s_cbranch_vccnz Lb_30
  s_waitcnt vmcnt(6)
  buffer_load_dwordx4 v[132:135], v1, s[32:35], s36 offen nt
  s_branch L_wo_j
Lb_14:
  buffer_load_dwordx4 v[68:71], v1, s[32:35], s36 offen nt
  s_add_u32 s36, s36, 1280
Lb_15:
  buffer_load_dwordx4 v[72:75], v1, s[32:35], s36 offen nt
  s_add_u32 s36, s36, 1280
Lb_16:
  buffer_load_dwordx4 v[76:79], v1, s[32:35], s36 offen nt
  s_add_u32 s36, s36, 1280
Lb_17:
  buffer_load_dwordx4 v[80:83], v1, s[32:35], s36 offen nt
  s_add_u32 s36, s36, 1280
Lb_18:
  buffer_load_dwordx4 v[84:87], v1, s[32:35], s36 offen nt
  s_add_u32 s36, s36, 1280
Lb_19:
  buffer_load_dwordx4 v[88:91], v1, s[32:35], s36 offen nt
  s_add_u32 s36, s36, 1280
Lb_20:
  buffer_load_dwordx4 v[92:95], v1, s[32:35], s36 offen nt
  s_add_u32 s36, s36, 1280
Lb_21:
  buffer_load_dwordx4 v[96:99], v1, s[32:35], s36 offen nt
  s_add_u32 s36, s36, 1280
Lb_22:
  buffer_load_dwordx4 v[100:103], v1, s[32:35], s36 offen nt
  s_add_u32 s36, s36, 1280
Lb_23:
  buffer_load_dwordx4 v[104:107], v1, s[32:35], s36 offen nt
  s_add_u32 s36, s36, 1280
Lb_24:
  buffer_load_dwordx4 v[108:111], v1, s[32:35], s36 offen nt
  s_add_u32 s36, s36, 1280
Lb_25:
  buffer_load_dwordx4 v[112:115], v1, s[32:35], s36 offen nt
  s_add_u32 s36, s36, 1280
Lb_26:
  buffer_load_dwordx4 v[116:119], v1, s[32:35], s36 offen nt
  s_add_u32 s36, s36, 1280
Lb_27:
  buffer_load_dwordx4 v[120:123], v1, s[32:35], s36 offen nt
  s_add_u32 s36, s36, 1280
Lb_28:
  buffer_load_dwordx4 v[124:127], v1, s[32:35], s36 offen nt
  s_add_u32 s36, s36, 1280
Lb_29:
  buffer_load_dwordx4 v[128:131], v1, s[32:35], s36 offen nt
  s_add_u32 s36, s36, 1280
Lb_30:
  buffer_load_dwordx4 v[132:135], v1, s[32:35], s36 offen nt
  s_branch L_wo_j
  s_branch L_wo_j
L_wo_e:
Lg_69:
  s_cmp_ge_u32 s57, s56
  s_cbranch_scc1 Lgo_70
  ds_read_b128 v[28:31], v24 offset:32
  s_waitcnt lgkmcnt(0)
  v_add3_u32 v28, v28, v29, v30
  v_add_u32 v28, v28, v31
  s_nop 0
  v_readfirstlane_b32 s57, v28
  s_mul_i32 s57, s57, 24
  s_cmp_ge_u32 s57, s56
  s_cbranch_scc1 Lgo_70
  s_sleep 1
  s_sub_u32 s26, s26, 1
  s_cbranch_scc0 Lg_69
  s_branch L_end
Lgo_70:
  s_add_u32 s56, s56, 72
  buffer_load_dwordx4 v[40:43], v1, s[32:35], s36 offen nt
  s_add_u32 s36, s36, 1280
Lg_71:
  s_cmp_ge_u32 s57, s56
  s_cbranch_scc1 Lgo_72
  ds_read_b128 v[28:31], v24 offset:32
  s_waitcnt lgkmcnt(0)
  v_add3_u32 v28, v28, v29, v30
  v_add_u32 v28, v28, v31
  s_nop 0
  v_readfirstlane_b32 s57, v28
  s_mul_i32 s57, s57, 24
  s_cmp_ge_u32 s57, s56
  s_cbranch_scc1 Lgo_72
  s_sleep 1
  s_sub_u32 s26, s26, 1
  s_cbranch_scc0 Lg_71
  s_branch L_end
Lgo_72:
  s_add_u32 s56, s56, 72
  buffer_load_dwordx4 v[44:47], v1, s[32:35], s36 offen nt
  s_add_u32 s36, s36, 1280
Lg_73:
  s_cmp_ge_u32 s57, s56
  s_cbranch_scc1 Lgo_74
  ds_read_b128 v[28:31], v24 offset:32
  s_waitcnt lgkmcnt(0)
  v_add3_u32 v28, v28, v29, v30
  v_add_u32 v28, v28, v31
  s_nop 0
  v_readfirstlane_b32 s57, v28
  s_mul_i32 s57, s57, 24
  s_cmp_ge_u32 s57, s56
  s_cbranch_scc1 Lgo_74
  s_sleep 1
  s_sub_u32 s26, s26, 1
  s_cbranch_scc0 Lg_73
  s_branch L_end
Lgo_74:
  s_add_u32 s56, s56, 72
  buffer_load_dwordx4 v[48:51], v1, s[32:35], s36 offen nt
  s_add_u32 s36, s36, 1280
Lg_75:
  s_cmp_ge_u32 s57, s56
  s_cbranch_scc1 Lgo_76
  ds_read_b128 v[28:31], v24 offset:32
  s_waitcnt lgkmcnt(0)
  v_add3_u32 v28, v28, v29, v30
  v_add_u32 v28, v28, v31
  s_nop 0
  v_readfirstlane_b32 s57, v28
  s_mul_i32 s57, s57, 24
  s_cmp_ge_u32 s57, s56
  s_cbranch_scc1 Lgo_76
  s_sleep 1
  s_sub_u32 s26, s26, 1
  s_cbranch_scc0 Lg_75
  s_branch L_end
L_pad4:
  s_branch L_p1done
Lgo_76:
  s_add_u32 s56, s56, 72
  buffer_load_dwordx4 v[52:55], v1, s[32:35], s36 offen nt
  s_add_u32 s36, s36, 1280
Lg_77:
  s_cmp_ge_u32 s57, s56
  s_cbranch_scc1 Lgo_78
  ds_read_b128 v[28:31], v24 offset:32
  s_waitcnt lgkmcnt(0)
  v_add3_u32 v28, v28, v29, v30
  v_add_u32 v28, v28, v31
  s_nop 0
  v_readfirstlane_b32 s57, v28
  s_mul_i32 s57, s57, 24
  s_cmp_ge_u32 s57, s56
  s_cbranch_scc1 Lgo_78
  s_sleep 1
  s_sub_u32 s26, s26, 1
  s_cbranch_scc0 Lg_77
  s_branch L_end
Lgo_78:
  s_add_u32 s56, s56, 72
  buffer_load_dwordx4 v[56:59], v1, s[32:35], s36 offen nt
  s_add_u32 s36, s36, 1280
Lg_79:
  s_cmp_ge_u32 s57, s56
  s_cbranch_scc1 Lgo_80
  ds_read_b128 v[28:31], v24 offset:32
  s_waitcnt lgkmcnt(0)
  v_add3_u32 v28, v28, v29, v30
  v_add_u32 v28, v28, v31
  s_nop 0
  v_readfirstlane_b32 s57, v28
  s_mul_i32 s57, s57, 24
  s_cmp_ge_u32 s57, s56
  s_cbranch_scc1 Lgo_80
  s_sleep 1
  s_sub_u32 s26, s26, 1
  s_cbranch_scc0 Lg_79
  s_branch L_end
Lgo_80:
  s_add_u32 s56, s56, 72
  buffer_load_dwordx4 v[60:63], v1, s[32:35], s36 offen nt
  s_add_u32 s36, s36, 1280
Lg_81:
  s_cmp_ge_u32 s57, s56
  s_cbranch_scc1 Lgo_82
  ds_read_b128 v[28:31], v24 offset:32
  s_waitcnt lgkmcnt(0)
  v_add3_u32 v28, v28, v29, v30
  v_add_u32 v28, v28, v31
  s_nop 0
  v_readfirstlane_b32 s57, v28
  s_mul_i32 s57, s57, 24
  s_cmp_ge_u32 s57, s56
  s_cbranch_scc1 Lgo_82
  s_sleep 1
  s_sub_u32 s26, s26, 1
  s_cbranch_scc0 Lg_81
  s_branch L_end
Lgo_82:
  s_add_u32 s56, s56, 72
  buffer_load_dwordx4 v[64:67], v1, s[32:35], s36 offen nt
  s_add_u32 s36, s36, 1280
Lg_83:
  s_cmp_ge_u32 s57, s56
  s_cbranch_scc1 Lgo_84
  ds_read_b128 v[28:31], v24 offset:32
  s_waitcnt lgkmcnt(0)
  v_add3_u32 v28, v28, v29, v30
  v_add_u32 v28, v28, v31
  s_nop 0
  v_readfirstlane_b32 s57, v28
  s_mul_i32 s57, s57, 24
  s_cmp_ge_u32 s57, s56
  s_cbranch_scc1 Lgo_84
  s_sleep 1
  s_sub_u32 s26, s26, 1
  s_cbranch_scc0 Lg_83
  s_branch L_end
Lgo_84:
  s_add_u32 s56, s56, 72
  buffer_load_dwordx4 v[68:71], v1, s[32:35], s36 offen nt
  s_add_u32 s36, s36, 1280
  ds_read_b128 v[28:31], v24 offset:160
  s_waitcnt lgkmcnt(0)
  v_and_b32 v28, v28, v29
  v_and_or_b32 v28, v28, v30, v31
  v_cmp_ne_u32 vcc, 0, v28
  s_cbranch_vccnz Lb_53
  s_waitcnt vmcnt(7)
  buffer_load_dwordx4 v[72:75], v1, s[32:35], s36 offen nt
  s_add_u32 s36, s36, 1280
  ds_read_b128 v[28:31], v24 offset:160
  s_waitcnt lgkmcnt(0)
  v_and_b32 v28, v28, v29
  v_and_or_b32 v28, v28, v30, v31
  v_cmp_ne_u32 vcc, 0, v28
  s_cbranch_vccnz Lb_54
  s_waitcnt vmcnt(7)
  buffer_load_dwordx4 v[76:79], v1, s[32:35], s36 offen nt
  s_add_u32 s36, s36, 1280
  ds_read_b128 v[28:31], v24 offset:160
  s_waitcnt lgkmcnt(0)
  v_and_b32 v28, v28, v29
  v_and_or_b32 v28, v28, v30, v31
  v_cmp_ne_u32 vcc, 0, v28
  s_cbranch_vccnz Lb_55
  s_waitcnt vmcnt(7)
  buffer_load_dwordx4 v[80:83], v1, s[32:35], s36 offen nt
  s_add_u32 s36, s36, 1280
  ds_read_b128 v[28:31], v24 offset:160
  s_waitcnt lgkmcnt(0)
  v_and_b32 v28, v28, v29
  v_and_or_b32 v28, v28, v30, v31
  v_cmp_ne_u32 vcc, 0, v28
  s_cbranch_vccnz Lb_56
  s_waitcnt vmcnt(7)
  buffer_load_dwordx4 v[84:87], v1, s[32:35], s36 offen nt
  s_add_u32 s36, s36, 1280
  ds_read_b128 v[28:31], v24 offset:160
  s_waitcnt lgkmcnt(0)
  v_and_b32 v28, v28, v29
  v_and_or_b32 v28, v28, v30, v31
  v_cmp_ne_u32 vcc, 0, v28
  s_cbranch_vccnz Lb_57
  s_waitcnt vmcnt(7)
  buffer_load_dwordx4 v[88:91], v1, s[32:35], s36 offen nt
  s_add_u32 s36, s36, 1280
  ds_read_b128 v[28:31], v24 offset:160
  s_waitcnt lgkmcnt(0)
  v_and_b32 v28, v28, v29
  v_and_or_b32 v28, v28, v30, v31
  v_cmp_ne_u32 vcc, 0, v28
  s_cbranch_vccnz Lb_58
  s_waitcnt vmcnt(7)
  buffer_load_dwordx4 v[92:95], v1, s[32:35], s36 offen nt
  s_add_u32 s36, s36, 1280
  ds_read_b128 v[28:31], v24 offset:160
  s_waitcnt lgkmcnt(0)
  v_and_b32 v28, v28, v29
  v_and_or_b32 v28, v28, v30, v31
  v_cmp_ne_u32 vcc, 0, v28
  s_cbranch_vccnz Lb_59
  s_waitcnt vmcnt(7)
  buffer_load_dwordx4 v[96:99], v1, s[32:35], s36 offen nt
  s_add_u32 s36, s36, 1280
  ds_read_b128 v[28:31], v24 offset:160
  s_waitcnt lgkmcnt(0)
  v_and_b32 v28, v28, v29
  v_and_or_b32 v28, v28, v30, v31
  v_cmp_ne_u32 vcc, 0, v28
  s_cbranch_vccnz Lb_60
  s_waitcnt vmcnt(7)
  buffer_load_dwordx4 v[100:103], v1, s[32:35], s36 offen nt
  s_add_u32 s36, s36, 1280
  ds_read_b128 v[28:31], v24 offset:160
  s_waitcnt lgkmcnt(0)
  v_and_b32 v28, v28, v29
  v_and_or_b32 v28, v28, v30, v31
  v_cmp_ne_u32 vcc, 0, v28
  s_cbranch_vccnz Lb_61
  s_waitcnt vmcnt(7)
  buffer_load_dwordx4 v[104:107], v1, s[32:35], s36 offen nt
  s_add_u32 s36, s36, 1280
  ds_read_b128 v[28:31], v24 offset:160
  s_waitcnt lgkmcnt(0)
  v_and_b32 v28, v28, v29
  v_and_or_b32 v28, v28, v30, v31
  v_cmp_ne_u32 vcc, 0, v28
  s_cbranch_vccnz Lb_62
  s_waitcnt vmcnt(7)
  buffer_load_dwordx4 v[108:111], v1, s[32:35], s36 offen nt
  s_add_u32 s36, s36, 1280
  ds_read_b128 v[28:31], v24 offset:160
  s_waitcnt lgkmcnt(0)
  v_and_b32 v28, v28, v29
  v_and_or_b32 v28, v28, v30, v31
  v_cmp_ne_u32 vcc, 0, v28
  s_cbranch_vccnz Lb_63
  s_waitcnt vmcnt(7)
  buffer_load_dwordx4 v[112:115], v1, s[32:35], s36 offen nt
  s_add_u32 s36, s36, 1280
  ds_read_b128 v[28:31], v24 offset:160
  s_waitcnt lgkmcnt(0)
  v_and_b32 v28, v28, v29
  v_and_or_b32 v28, v28, v30, v31
  v_cmp_ne_u32 vcc, 0, v28
  s_cbranch_vccnz Lb_64
  s_waitcnt vmcnt(7)
  buffer_load_dwordx4 v[116:119], v1, s[32:35], s36 offen nt
  s_branch L_pad5_x
L_pad5:
  s_branch L_pad11
L_pad5_x:
  s_add_u32 s36, s36, 1280
  ds_read_b128 v[28:31], v24 offset:160
  s_waitcnt lgkmcnt(0)
  v_and_b32 v28, v28, v29
  v_and_or_b32 v28, v28, v30, v31
  v_cmp_ne_u32 vcc, 0, v28
  s_cbranch_vccnz Lb_65
  s_waitcnt vmcnt(7)
  buffer_load_dwordx4 v[120:123], v1, s[32:35], s36 offen nt
  s_add_u32 s36, s36, 1280
  ds_read_b128 v[28:31], v24 offset:160
  s_waitcnt lgkmcnt(0)
  v_and_b32 v28, v28, v29
  v_and_or_b32 v28, v28, v30, v31
  v_cmp_ne_u32 vcc, 0, v28
  s_cbranch_vccnz Lb_66
  s_waitcnt vmcnt(7)
  buffer_load_dwordx4 v[124:127], v1, s[32:35], s36 offen nt
  s_add_u32 s36, s36, 1280
  ds_read_b128 v[28:31], v24 offset:160
  s_waitcnt lgkmcnt(0)
  v_and_b32 v28, v28, v29
  v_and_or_b32 v28, v28, v30, v31
  v_cmp_ne_u32 vcc, 0, v28
  s_cbranch_vccnz Lb_67
  s_waitcnt vmcnt(7)
  buffer_load_dwordx4 v[128:131], v1, s[32:35], s36 offen nt
  s_add_u32 s36, s36, 1280
  ds_read_b128 v[28:31], v24 offset:160
  s_waitcnt lgkmcnt(0)
  v_and_b32 v28, v28, v29
  v_and_or_b32 v28, v28, v30, v31
  v_cmp_ne_u32 vcc, 0, v28
  s_cbranch_vccnz Lb_68
  s_waitcnt vmcnt(7)
  buffer_load_dwordx4 v[132:135], v1, s[32:35], s36 offen nt
  s_branch L_wo_j
Lb_53:
  buffer_load_dwordx4 v[72:75], v1, s[32:35], s36 offen nt
  s_add_u32 s36, s36, 1280
Lb_54:
  buffer_load_dwordx4 v[76:79], v1, s[32:35], s36 offen nt
  s_add_u32 s36, s36, 1280
Lb_55:
  buffer_load_dwordx4 v[80:83], v1, s[32:35], s36 offen nt
  s_add_u32 s36, s36, 1280
Lb_56:
  buffer_load_dwordx4 v[84:87], v1, s[32:35], s36 offen nt
  s_add_u32 s36, s36, 1280
Lb_57:
  buffer_load_dwordx4 v[88:91], v1, s[32:35], s36 offen nt
  s_add_u32 s36, s36, 1280
Lb_58:
  buffer_load_dwordx4 v[92:95], v1, s[32:35], s36 offen nt
  s_add_u32 s36, s36, 1280
Lb_59:
  buffer_load_dwordx4 v[96:99], v1, s[32:35], s36 offen nt
  s_add_u32 s36, s36, 1280
Lb_60:
  buffer_load_dwordx4 v[100:103], v1, s[32:35], s36 offen nt
  s_add_u32 s36, s36, 1280
Lb_61:
  buffer_load_dwordx4 v[104:107], v1, s[32:35], s36 offen nt
  s_add_u32 s36, s36, 1280
Lb_62:
  buffer_load_dwordx4 v[108:111], v1, s[32:35], s36 offen nt
  s_add_u32 s36, s36, 1280
Lb_63:
  buffer_load_dwordx4 v[112:115], v1, s[32:35], s36 offen nt
  s_add_u32 s36, s36, 1280
Lb_64:
  buffer_load_dwordx4 v[116:119], v1, s[32:35], s36 offen nt
  s_add_u32 s36, s36, 1280
Lb_65:
  buffer_load_dwordx4 v[120:123], v1, s[32:35], s36 offen nt
  s_add_u32 s36, s36, 1280
Lb_66:
  buffer_load_dwordx4 v[124:127], v1, s[32:35], s36 offen nt
  s_add_u32 s36, s36, 1280
Lb_67:
  buffer_load_dwordx4 v[128:131], v1, s[32:35], s36 offen nt
  s_add_u32 s36, s36, 1280
Lb_68:
  buffer_load_dwordx4 v[132:135], v1, s[32:35], s36 offen nt
  s_branch L_wo_j
L_wo_j:
  s_setprio 3
  v_lshrrev_b32 v2, 4, v0
  v_and_b32 v8, 1, v0
  v_lshl_add_u32 v2, v2, 1, v8
  v_mul_u32_u24 v2, 48, v2
  v_and_b32 v160, 7, v0
  v_lshrrev_b32 v162, 5, v0
  v_lshl_add_u32 v160, v160, 1, v162
  v_and_b32 v162, 7, v160
  v_lshrrev_b32 v160, 3, v160
  v_mul_u32_u24 v160, 4096, v160
  v_lshl_add_u32 v160, v162, 4, v160
  s_mul_i32 s36, s6, 10
  s_add_u32 s36, s36, s52
  s_lshl_b32 s36, s36, 14
  s_mul_i32 s37, s7, 128
  s_add_u32 s36, s36, s37
  s_add_u32 s36, s36, 524288
  v_mov_b32 v29, 0
Lw_85:
  ds_read_b128 v[24:27], v29 offset:160
  s_waitcnt lgkmcnt(0)
  v_xor_b32 v28, s25, v24
  v_xor_b32 v29, s25, v25
  v_or_b32 v28, v28, v29
  v_xor_b32 v29, s25, v26
  v_or_b32 v28, v28, v29
  v_mov_b32 v29, 0
  v_cmp_ne_u32 vcc, 0, v28
  s_cmp_eq_u64 vcc, 0
  s_cbranch_scc1 Lwd_86
  s_sleep 1
  s_sub_u32 s26, s26, 1
  s_cbranch_scc0 Lw_85
  s_branch L_end
Lwd_86:
  ds_read_b128 v[24:27], v2 offset:1152
  ds_read_b128 v[28:31], v2 offset:1168
  ds_read_b128 v[32:35], v2 offset:1184
  s_waitcnt lgkmcnt(0)
L_fc:
  v_perm_b32 v8, v24, v24, v16
  v_perm_b32 v9, v24, v24, v18
  v_perm_b32 v10, v24, v24, v20
  v_perm_b32 v11, v24, v24, v22
  v_perm_b32 v12, v24, v24, v17
  v_perm_b32 v13, v24, v24, v19
  v_perm_b32 v14, v24, v24, v21
  v_perm_b32 v15, v24, v24, v23
  s_waitcnt vmcnt(23)
  v_mfma_f32_16x16x32_bf16 v[4:7], v[8:11], v[40:43], 0
  v_perm_b32 v8, v25, v25, v16
  v_perm_b32 v9, v25, v25, v18
  v_perm_b32 v10, v25, v25, v20
  v_perm_b32 v11, v25, v25, v22
  s_waitcnt vmcnt(22)
  v_mfma_f32_16x16x32_bf16 v[4:7], v[12:15], v[44:47], v[4:7]
  v_perm_b32 v12, v25, v25, v17
  v_perm_b32 v13, v25, v25, v19
  v_perm_b32 v14, v25, v25, v21
  v_perm_b32 v15, v25, v25, v23
  s_waitcnt vmcnt(21)
  v_mfma_f32_16x16x32_bf16 v[4:7], v[8:11], v[48:51], v[4:7]
  v_perm_b32 v8, v26, v26, v16
  v_perm_b32 v9, v26, v26, v18
  v_perm_b32 v10, v26, v26, v20
  v_perm_b32 v11, v26, v26, v22
  s_waitcnt vmcnt(20)
  v_mfma_f32_16x16x32_bf16 v[4:7], v[12:15], v[52:55], v[4:7]
  v_perm_b32 v12, v26, v26, v17
  v_perm_b32 v13, v26, v26, v19
  v_perm_b32 v14, v26, v26, v21
  v_perm_b32 v15, v26, v26, v23
  s_waitcnt vmcnt(19)
  v_mfma_f32_16x16x32_bf16 v[4:7], v[8:11], v[56:59], v[4:7]
  v_perm_b32 v8, v27, v27, v16
  v_perm_b32 v9, v27, v27, v18
  v_perm_b32 v10, v27, v27, v20
  v_perm_b32 v11, v27, v27, v22
  s_waitcnt vmcnt(18)
  v_mfma_f32_16x16x32_bf16 v[4:7], v[12:15], v[60:63], v[4:7]
  v_perm_b32 v12, v27, v27, v17
  v_perm_b32 v13, v27, v27, v19
  v_perm_b32 v14, v27, v27, v21
  v_perm_b32 v15, v27, v27, v23
  s_waitcnt vmcnt(17)
  v_mfma_f32_16x16x32_bf16 v[4:7], v[8:11], v[64:67], v[4:7]
  v_perm_b32 v8, v28, v28, v16
  v_perm_b32 v9, v28, v28, v18
  v_perm_b32 v10, v28, v28, v20
  s_branch L_pad6_x
L_pad6:
  s_branch L_pad12
L_pad6_x:
  v_perm_b32 v11, v28, v28, v22
  s_waitcnt vmcnt(16)
  v_mfma_f32_16x16x32_bf16 v[4:7], v[12:15], v[68:71], v[4:7]
  v_perm_b32 v12, v28, v28, v17
  v_perm_b32 v13, v28, v28, v19
  v_perm_b32 v14, v28, v28, v21
  v_perm_b32 v15, v28, v28, v23
  s_waitcnt vmcnt(15)
  v_mfma_f32_16x16x32_bf16 v[4:7], v[8:11], v[72:75], v[4:7]
  v_perm_b32 v8, v29, v29, v16
  v_perm_b32 v9, v29, v29, v18
  v_perm_b32 v10, v29, v29, v20
  v_perm_b32 v11, v29, v29, v22
  s_waitcnt vmcnt(14)
  v_mfma_f32_16x16x32_bf16 v[4:7], v[12:15], v[76:79], v[4:7]
  v_perm_b32 v12, v29, v29, v17
  v_perm_b32 v13, v29, v29, v19
  v_perm_b32 v14, v29, v29, v21
  v_perm_b32 v15, v29, v29, v23
  s_waitcnt vmcnt(13)
  v_mfma_f32_16x16x32_bf16 v[4:7], v[8:11], v[80:83], v[4:7]
  v_perm_b32 v8, v30, v30, v16
  v_perm_b32 v9, v30, v30, v18
  v_perm_b32 v10, v30, v30, v20
  v_perm_b32 v11, v30, v30, v22
  s_waitcnt vmcnt(12)
  v_mfma_f32_16x16x32_bf16 v[4:7], v[12:15], v[84:87], v[4:7]
  v_perm_b32 v12, v30, v30, v17
  v_perm_b32 v13, v30, v30, v19
  v_perm_b32 v14, v30, v30, v21
  v_perm_b32 v15, v30, v30, v23
  s_waitcnt vmcnt(11)
  v_mfma_f32_16x16x32_bf16 v[4:7], v[8:11], v[88:91], v[4:7]
  v_perm_b32 v8, v31, v31, v16
  v_perm_b32 v9, v31, v31, v18
  v_perm_b32 v10, v31, v31, v20
  v_perm_b32 v11, v31, v31, v22
  s_waitcnt vmcnt(10)
  v_mfma_f32_16x16x32_bf16 v[4:7], v[12:15], v[92:95], v[4:7]
  v_perm_b32 v12, v31, v31, v17
  v_perm_b32 v13, v31, v31, v19
  v_perm_b32 v14, v31, v31, v21
  v_perm_b32 v15, v31, v31, v23
  s_waitcnt vmcnt(9)
  v_mfma_f32_16x16x32_bf16 v[4:7], v[8:11], v[96:99], v[4:7]
  v_perm_b32 v8, v32, v32, v16
  v_perm_b32 v9, v32, v32, v18
  v_perm_b32 v10, v32, v32, v20
  v_perm_b32 v11, v32, v32, v22
  s_waitcnt vmcnt(8)
  v_mfma_f32_16x16x32_bf16 v[4:7], v[12:15], v[100:103], v[4:7]
  v_perm_b32 v12, v32, v32, v17
  v_perm_b32 v13, v32, v32, v19
  v_perm_b32 v14, v32, v32, v21
  v_perm_b32 v15, v32, v32, v23
  s_waitcnt vmcnt(7)
  v_mfma_f32_16x16x32_bf16 v[4:7], v[8:11], v[104:107], v[4:7]
  v_perm_b32 v8, v33, v33, v16
  v_perm_b32 v9, v33, v33, v18
  v_perm_b32 v10, v33, v33, v20
  v_perm_b32 v11, v33, v33, v22
  s_waitcnt vmcnt(6)
  v_mfma_f32_16x16x32_bf16 v[4:7], v[12:15], v[108:111], v[4:7]
  v_perm_b32 v12, v33, v33, v17
  v_perm_b32 v13, v33, v33, v19
  v_perm_b32 v14, v33, v33, v21
  v_perm_b32 v15, v33, v33, v23
  s_waitcnt vmcnt(5)
  v_mfma_f32_16x16x32_bf16 v[4:7], v[8:11], v[112:115], v[4:7]
  v_perm_b32 v8, v34, v34, v16
  v_perm_b32 v9, v34, v34, v18
  v_perm_b32 v10, v34, v34, v20
  v_perm_b32 v11, v34, v34, v22
  s_waitcnt vmcnt(4)
  v_mfma_f32_16x16x32_bf16 v[4:7], v[12:15], v[116:119], v[4:7]
  v_perm_b32 v12, v34, v34, v17
  v_perm_b32 v13, v34, v34, v19
  v_perm_b32 v14, v34, v34, v21
  v_perm_b32 v15, v34, v34, v23
  s_waitcnt vmcnt(3)
  v_mfma_f32_16x16x32_bf16 v[4:7], v[8:11], v[120:123], v[4:7]
  v_perm_b32 v8, v35, v35, v16
  v_perm_b32 v9, v35, v35, v18
  v_perm_b32 v10, v35, v35, v20
  v_perm_b32 v11, v35, v35, v22
  s_waitcnt vmcnt(2)
  v_mfma_f32_16x16x32_bf16 v[4:7], v[12:15], v[124:127], v[4:7]
  v_perm_b32 v12, v35, v35, v17
  v_perm_b32 v13, v35, v35, v19
  v_perm_b32 v14, v35, v35, v21
  v_perm_b32 v15, v35, v35, v23
  s_waitcnt vmcnt(1)
  v_mfma_f32_16x16x32_bf16 v[4:7], v[8:11], v[128:131], v[4:7]
  s_nop 1
  s_waitcnt vmcnt(0)
  v_mfma_f32_16x16x32_bf16 v[4:7], v[12:15], v[132:135], v[4:7]
  s_nop 7
  v_add_f32_dpp v24, v5, v4 row_ror:8 row_mask:0xf bank_mask:0xf
  v_add_f32_dpp v25, v7, v6 row_ror:8 row_mask:0xf bank_mask:0xf
  v_mov_b32 v26, 0
  v_mov_b32 v27, 0
  s_nop 1
  v_permlane16_swap_b32 v24, v26
  v_permlane16_swap_b32 v25, v27
  s_nop 1
  v_perm_b32 v24, v24, v3, s40
  v_perm_b32 v25, v25, v3, s41
  v_perm_b32 v26, v26, v3, s42
  v_perm_b32 v27, v27, v3, s43
  s_mov_b32 exec_lo, 0xff
  s_mov_b32 exec_hi, 0xff
  buffer_store_dwordx4 v[24:27], v160, s[28:31], s36 offen sc1
  s_add_u32 s36, s36, 8192
  buffer_store_dwordx4 v[24:27], v160, s[28:31], s36 offen sc1
  s_mov_b64 exec, -1
L_w_fin:
  ds_write_b32 v161, v3 offset:176
  s_branch L_end
.p2align 12
L_pad7:
  s_branch L_p1done
L_k:
  s_setprio 2
  s_sub_u32 s27, s24, 4
  v_and_b32 v1, 7, v0
  v_mul_u32_u24 v1, 384, v1
  v_bfe_u32 v8, v0, 3, 1
  v_lshl_add_u32 v1, v8, 6, v1
  v_lshrrev_b32 v8, 4, v0
  v_lshl_add_u32 v1, v8, 4, v1
  v_and_b32 v2, 3, v0
  v_lshlrev_b32 v2, 4, v2
  v_and_b32 v6, 1, v8
  v_lshl_add_u32 v6, v6, 6, v2
  v_lshl_add_u32 v2, v8, 6, v2
  s_mul_i32 s36, s7, 1572864
  s_mul_i32 s37, s5, 98304
  s_add_u32 s36, s36, s37
  s_mul_i32 s37, s27, 24576
  s_add_u32 s36, s36, s37
  s_add_u32 s36, s36, 1179648
  v_bfe_u32 v1, v0, 2, 2
  v_mul_u32_u24 v1, 384, v1
  v_and_b32 v8, 3, v0
  v_lshl_add_u32 v1, v8, 4, v1
  v_lshrrev_b32 v8, 5, v0
  v_mul_u32_u24 v7, 1536, v8
  v_add_u32 v7, v7, v1
  v_bfe_u32 v8, v0, 4, 1
  v_lshl_add_u32 v7, v8, 6, v7
  v_lshrrev_b32 v8, 4, v0
  v_lshl_add_u32 v1, v8, 6, v1
  s_mov_b32 s32, s14
  s_and_b32 s33, s15, 0xffff
  s_mov_b32 s34, 50331648
  s_mov_b32 s35, 0x00020000
  s_mov_b32 s28, s22
  s_and_b32 s29, s23, 0xffff
  s_mov_b32 s30, 268435456
  s_mov_b32 s31, 0x00020000
  s_waitcnt lgkmcnt(0)
  s_mul_i32 s25, s25, 0x9E3779B1
  s_add_u32 s25, s25, 0x7F4A7C15
  s_andn2_b32 s25, s25, 15
  s_or_b32 s25, s25, 8
  s_or_b32 s25, s25, s60
  v_mov_b32 v3, s25
  v_mov_b32 v152, 0
  v_mov_b32 v153, 0
  v_mov_b32 v154, 0
  v_mov_b32 v155, 0
  v_mov_b32 v156, 0
  v_mov_b32 v157, 0
  v_mov_b32 v158, 0
  v_mov_b32 v159, 0
  v_mov_b32 v160, 0
  v_mov_b32 v161, 0
  v_mov_b32 v162, 0
  v_mov_b32 v163, 0
  v_mov_b32 v164, 0
  v_mov_b32 v165, 0
  v_mov_b32 v166, 0
  v_mov_b32 v167, 0
  v_mov_b32 v16, 0
  v_mov_b32 v17, 0
  v_mov_b32 v18, 0
  v_mov_b32 v19, 0
  v_mov_b32 v20, 0
  v_mov_b32 v21, 0
  v_mov_b32 v22, 0
  v_mov_b32 v23, 0
  v_bfe_u32 v5, v0, 2, 3
  v_lshlrev_b32 v5, 6, v5
  v_and_b32 v4, 3, v0
  v_lshl_add_u32 v5, v4, 2, v5
  v_lshrrev_b32 v4, 5, v0
  v_lshl_add_u32 v5, v4, 1, v5
  s_lshl_b32 s37, s27, 4
  v_add_u32 v5, s37, v5
  s_add_u32 s56, s27, 1
  s_mul_i32 s56, s56, 24
  s_mov_b32 s57, 0
  v_mov_b32 v24, 0
Lg_111:
  s_cmp_ge_u32 s57, s56
  s_cbranch_scc1 Lgo_112
  ds_read_b128 v[28:31], v24 offset:0
  s_waitcnt lgkmcnt(0)
  v_add3_u32 v28, v28, v29, v30
  v_add_u32 v28, v28, v31
  s_nop 0
  v_readfirstlane_b32 s57, v28
  s_mul_i32 s57, s57, 24
  s_cmp_ge_u32 s57, s56
  s_cbranch_scc1 Lgo_112
  s_sleep 1
  s_sub_u32 s26, s26, 1
  s_cbranch_scc0 Lg_111
  s_branch L_end
Lgo_112:
  s_add_u32 s56, s56, 96
  buffer_load_dwordx4 v[40:43], v1, s[32:35], s36 offen offset:0 nt
Lg_113:
  s_cmp_ge_u32 s57, s56
  s_cbranch_scc1 Lgo_114
  ds_read_b128 v[28:31], v24 offset:0
  s_waitcnt lgkmcnt(0)
  v_add3_u32 v28, v28, v29, v30
  v_add_u32 v28, v28, v31
  s_nop 0
  v_readfirstlane_b32 s57, v28
  s_mul_i32 s57, s57, 24
  s_cmp_ge_u32 s57, s56
  s_cbranch_scc1 Lgo_114
  s_sleep 1
  s_sub_u32 s26, s26, 1
  s_cbranch_scc0 Lg_113
  s_branch L_end
Lgo_114:
  s_add_u32 s56, s56, 96
  buffer_load_dwordx4 v[44:47], v1, s[32:35], s36 offen offset:1536 nt
Lg_115:
  s_cmp_ge_u32 s57, s56
  s_cbranch_scc1 Lgo_116
  ds_read_b128 v[28:31], v24 offset:0
  s_waitcnt lgkmcnt(0)
  v_add3_u32 v28, v28, v29, v30
  v_add_u32 v28, v28, v31
  s_nop 0
  v_readfirstlane_b32 s57, v28
  s_mul_i32 s57, s57, 24
  s_cmp_ge_u32 s57, s56
  s_cbranch_scc1 Lgo_116
  s_sleep 1
  s_sub_u32 s26, s26, 1
  s_cbranch_scc0 Lg_115
  s_branch L_end
Lgo_116:
  s_add_u32 s56, s56, 96
  buffer_load_dwordx4 v[48:51], v7, s[32:35], s36 offen offset:256 nt
  s_add_u32 s36, s36, 3072
Lg_117:
  s_cmp_ge_u32 s57, s56
  s_cbranch_scc1 Lgo_118
  ds_read_b128 v[28:31], v24 offset:0
  s_waitcnt lgkmcnt(0)
  v_add3_u32 v28, v28, v29, v30
  v_add_u32 v28, v28, v31
  s_nop 0
  v_readfirstlane_b32 s57, v28
  s_mul_i32 s57, s57, 24
  s_cmp_ge_u32 s57, s56
  s_cbranch_scc1 Lgo_118
  s_sleep 1
  s_sub_u32 s26, s26, 1
  s_cbranch_scc0 Lg_117
  s_branch L_end
Lgo_118:
  s_add_u32 s56, s56, 96
  buffer_load_dwordx4 v[52:55], v1, s[32:35], s36 offen offset:0 nt
Lg_119:
  s_cmp_ge_u32 s57, s56
  s_cbranch_scc1 Lgo_120
  ds_read_b128 v[28:31], v24 offset:0
  s_waitcnt lgkmcnt(0)
  v_add3_u32 v28, v28, v29, v30
  v_add_u32 v28, v28, v31
  s_nop 0
  v_readfirstlane_b32 s57, v28
  s_mul_i32 s57, s57, 24
  s_cmp_ge_u32 s57, s56
  s_cbranch_scc1 Lgo_120
  s_sleep 1
  s_sub_u32 s26, s26, 1
  s_cbranch_scc0 Lg_119
  s_branch L_end
Lgo_120:
  s_add_u32 s56, s56, 96
  buffer_load_dwordx4 v[56:59], v1, s[32:35], s36 offen offset:1536 nt
Lg_121:
  s_cmp_ge_u32 s57, s56
  s_cbranch_scc1 Lgo_122
  ds_read_b128 v[28:31], v24 offset:0
  s_waitcnt lgkmcnt(0)
  v_add3_u32 v28, v28, v29, v30
  v_add_u32 v28, v28, v31
  s_nop 0
  v_readfirstlane_b32 s57, v28
  s_mul_i32 s57, s57, 24
  s_cmp_ge_u32 s57, s56
  s_cbranch_scc1 Lgo_122
  s_sleep 1
  s_sub_u32 s26, s26, 1
  s_cbranch_scc0 Lg_121
  s_branch L_end
L_pad8:
  s_branch L_p1done
Lgo_122:
  s_add_u32 s56, s56, 96
  buffer_load_dwordx4 v[60:63], v7, s[32:35], s36 offen offset:256 nt
  s_add_u32 s36, s36, 3072
  s_waitcnt vmcnt(5)
  buffer_load_dwordx4 v[64:67], v1, s[32:35], s36 offen offset:0 nt
  s_waitcnt vmcnt(5)
  buffer_load_dwordx4 v[68:71], v1, s[32:35], s36 offen offset:1536 nt
  s_waitcnt vmcnt(5)
  buffer_load_dwordx4 v[72:75], v7, s[32:35], s36 offen offset:256 nt
  s_add_u32 s36, s36, 3072
  s_waitcnt vmcnt(5)
  buffer_load_dwordx4 v[76:79], v1, s[32:35], s36 offen offset:0 nt
  s_waitcnt vmcnt(5)
  buffer_load_dwordx4 v[80:83], v1, s[32:35], s36 offen offset:1536 nt
  s_waitcnt vmcnt(5)
  buffer_load_dwordx4 v[84:87], v7, s[32:35], s36 offen offset:256 nt
  s_add_u32 s36, s36, 3072
  s_waitcnt vmcnt(5)
  buffer_load_dwordx4 v[88:91], v1, s[32:35], s36 offen offset:0 nt
  s_waitcnt vmcnt(5)
  buffer_load_dwordx4 v[92:95], v1, s[32:35], s36 offen offset:1536 nt
  s_waitcnt vmcnt(5)
  buffer_load_dwordx4 v[96:99], v7, s[32:35], s36 offen offset:256 nt
  s_add_u32 s36, s36, 3072
  s_waitcnt vmcnt(5)
  buffer_load_dwordx4 v[100:103], v1, s[32:35], s36 offen offset:0 nt
  s_waitcnt vmcnt(5)
  buffer_load_dwordx4 v[104:107], v1, s[32:35], s36 offen offset:1536 nt
  s_waitcnt vmcnt(5)
  buffer_load_dwordx4 v[108:111], v7, s[32:35], s36 offen offset:256 nt
  s_add_u32 s36, s36, 3072
  s_waitcnt vmcnt(5)
  buffer_load_dwordx4 v[112:115], v1, s[32:35], s36 offen offset:0 nt
  s_waitcnt vmcnt(5)
  buffer_load_dwordx4 v[116:119], v1, s[32:35], s36 offen offset:1536 nt
  s_waitcnt vmcnt(5)
  buffer_load_dwordx4 v[120:123], v7, s[32:35], s36 offen offset:256 nt
  s_add_u32 s36, s36, 3072
  s_waitcnt vmcnt(5)
  buffer_load_dwordx4 v[124:127], v1, s[32:35], s36 offen offset:0 nt
  s_waitcnt vmcnt(5)
  buffer_load_dwordx4 v[128:131], v1, s[32:35], s36 offen offset:1536 nt
  s_waitcnt vmcnt(5)
  buffer_load_dwordx4 v[132:135], v7, s[32:35], s36 offen offset:256 nt
  s_setprio 3
  s_lshl_b32 s37, s27, 2
  v_mov_b32 v8, s37
  s_waitcnt vmcnt(5)
  v_mov_b32 v9, 1
  ds_write_b32 v8, v9 offset:16
  s_waitcnt vmcnt(4)
  v_mov_b32 v9, 2
  ds_write_b32 v8, v9 offset:16
  s_waitcnt vmcnt(3)
  v_mov_b32 v9, 3
  ds_write_b32 v8, v9 offset:16
  s_waitcnt vmcnt(2)
  v_mov_b32 v9, 4
  ds_write_b32 v8, v9 offset:16
  s_waitcnt vmcnt(1)
  v_mov_b32 v9, 5
  ds_write_b32 v8, v9 offset:16
  s_waitcnt vmcnt(0)
  v_mov_b32 v9, 6
  ds_write_b32 v8, v9 offset:16
  s_setprio 3
  v_mov_b32 v29, 0
Lw_123:
  ds_read_b128 v[24:27], v29 offset:48
  s_waitcnt lgkmcnt(0)
  v_xor_b32 v28, s25, v24
  v_xor_b32 v29, s25, v25
  v_or_b32 v28, v28, v29
  v_xor_b32 v29, s25, v26
  v_or_b32 v28, v28, v29
  v_mov_b32 v29, 0
  v_cmp_ne_u32 vcc, 0, v28
  s_cmp_eq_u64 vcc, 0
  s_cbranch_scc1 Lwd_124
  s_sleep 1
  s_sub_u32 s26, s26, 1
  s_cbranch_scc0 Lw_123
  s_branch L_end
Lwd_124:
  s_mov_b32 exec_lo, 0xf000f
  s_mov_b32 exec_hi, 0xf000f
  ds_read_b128 v[152:155], v2 offset:256
  s_mov_b32 exec_lo, 0xf000f0
  s_mov_b32 exec_hi, 0xf000f0
  ds_read_b128 v[156:159], v2 offset:256
  s_mov_b32 exec_lo, 0xf000f
  s_mov_b32 exec_hi, 0xf000f0
  ds_read_b128 v[160:163], v6 offset:512
  s_mov_b32 exec_lo, 0xf000f00
  s_mov_b32 exec_hi, 0xf000f00
  ds_read_b128 v[164:167], v2 offset:256
  s_mov_b32 exec_lo, 0xf000f000
  s_mov_b32 exec_hi, 0xf000f000
  ds_read_b128 v[16:19], v2 offset:256
  s_mov_b32 exec_lo, 0xf000f00
  s_mov_b32 exec_hi, 0xf000f000
  ds_read_b128 v[20:23], v6 offset:512
  s_mov_b64 exec, -1
  s_mov_b32 s84, 0x22222222
  s_mov_b32 s85, 0x22222222
  s_mov_b32 s86, 0x44444444
  s_mov_b32 s87, 0x44444444
  s_mov_b32 s88, 0x88888888
  s_mov_b32 s89, 0x88888888
  s_waitcnt lgkmcnt(0)
  s_waitcnt vmcnt(23)
  v_mfma_f32_16x16x32_bf16 v[136:139], v[152:155], v[40:43], 0
  s_waitcnt vmcnt(22)
  v_mfma_f32_16x16x32_bf16 v[136:139], v[156:159], v[44:47], v[136:139]
  s_waitcnt vmcnt(21)
  v_mfma_f32_16x16x32_bf16 v[136:139], v[160:163], v[48:51], v[136:139]
  s_waitcnt vmcnt(20)
  v_mfma_f32_16x16x32_bf16 v[136:139], v[164:167], v[52:55], v[136:139]
  s_waitcnt vmcnt(19)
  v_mfma_f32_16x16x32_bf16 v[136:139], v[16:19], v[56:59], v[136:139]
  s_waitcnt vmcnt(18)
  v_mfma_f32_16x16x32_bf16 v[136:139], v[20:23], v[60:63], v[136:139]
  s_waitcnt vmcnt(17)
  v_mfma_f32_16x16x32_bf16 v[140:143], v[152:155], v[64:67], 0
  s_waitcnt vmcnt(16)
  v_mfma_f32_16x16x32_bf16 v[140:143], v[156:159], v[68:71], v[140:143]
  s_waitcnt vmcnt(15)
  v_mfma_f32_16x16x32_bf16 v[140:143], v[160:163], v[72:75], v[140:143]
  s_waitcnt vmcnt(14)
  v_mfma_f32_16x16x32_bf16 v[140:143], v[164:167], v[76:79], v[140:143]
  s_waitcnt vmcnt(13)
  v_mfma_f32_16x16x32_bf16 v[140:143], v[16:19], v[80:83], v[140:143]
  s_waitcnt vmcnt(12)
  v_mfma_f32_16x16x32_bf16 v[140:143], v[20:23], v[84:87], v[140:143]
  v_mov_b32_dpp v24, v136 quad_perm:[0,0,0,0] row_mask:0xf bank_mask:0xf
  v_add_f32_dpp v24, v137, v24 quad_perm:[1,1,1,1] row_mask:0xf bank_mask:0xf
  v_add_f32_dpp v24, v138, v24 quad_perm:[2,2,2,2] row_mask:0xf bank_mask:0xf
  v_add_f32_dpp v24, v139, v24 quad_perm:[3,3,3,3] row_mask:0xf bank_mask:0xf
  s_waitcnt vmcnt(11)
  v_mfma_f32_16x16x32_bf16 v[144:147], v[152:155], v[88:91], 0
  s_waitcnt vmcnt(10)
  v_mfma_f32_16x16x32_bf16 v[144:147], v[156:159], v[92:95], v[144:147]
  s_waitcnt vmcnt(9)
  v_mfma_f32_16x16x32_bf16 v[144:147], v[160:163], v[96:99], v[144:147]
  s_waitcnt vmcnt(8)
  v_mfma_f32_16x16x32_bf16 v[144:147], v[164:167], v[100:103], v[144:147]
  s_waitcnt vmcnt(7)
  v_mfma_f32_16x16x32_bf16 v[144:147], v[16:19], v[104:107], v[144:147]
  s_waitcnt vmcnt(6)
  v_mfma_f32_16x16x32_bf16 v[144:147], v[20:23], v[108:111], v[144:147]
  v_mov_b32_dpp v25, v140 quad_perm:[0,0,0,0] row_mask:0xf bank_mask:0xf
  v_add_f32_dpp v25, v141, v25 quad_perm:[1,1,1,1] row_mask:0xf bank_mask:0xf
  v_add_f32_dpp v25, v142, v25 quad_perm:[2,2,2,2] row_mask:0xf bank_mask:0xf
  v_add_f32_dpp v25, v143, v25 quad_perm:[3,3,3,3] row_mask:0xf bank_mask:0xf
  v_cndmask_b32_e64 v24, v24, v25, s[84:85]
  s_waitcnt vmcnt(5)
  v_mfma_f32_16x16x32_bf16 v[148:151], v[152:155], v[112:115], 0
  s_waitcnt vmcnt(4)
  v_mfma_f32_16x16x32_bf16 v[148:151], v[156:159], v[116:119], v[148:151]
  s_waitcnt vmcnt(3)
  s_branch L_pad9_x
L_pad9:
  s_branch L_p1done
L_pad9_x:
  v_mfma_f32_16x16x32_bf16 v[148:151], v[160:163], v[120:123], v[148:151]
  s_waitcnt vmcnt(2)
  v_mfma_f32_16x16x32_bf16 v[148:151], v[164:167], v[124:127], v[148:151]
  s_waitcnt vmcnt(1)
  v_mfma_f32_16x16x32_bf16 v[148:151], v[16:19], v[128:131], v[148:151]
  s_waitcnt vmcnt(0)
  v_mfma_f32_16x16x32_bf16 v[148:151], v[20:23], v[132:135], v[148:151]
  v_mov_b32_dpp v26, v144 quad_perm:[0,0,0,0] row_mask:0xf bank_mask:0xf
  v_add_f32_dpp v26, v145, v26 quad_perm:[1,1,1,1] row_mask:0xf bank_mask:0xf
  v_add_f32_dpp v26, v146, v26 quad_perm:[2,2,2,2] row_mask:0xf bank_mask:0xf
  v_add_f32_dpp v26, v147, v26 quad_perm:[3,3,3,3] row_mask:0xf bank_mask:0xf
  v_cndmask_b32_e64 v24, v24, v26, s[86:87]
  s_nop 7
  v_mov_b32_dpp v27, v148 quad_perm:[0,0,0,0] row_mask:0xf bank_mask:0xf
  v_add_f32_dpp v27, v149, v27 quad_perm:[1,1,1,1] row_mask:0xf bank_mask:0xf
  v_add_f32_dpp v27, v150, v27 quad_perm:[2,2,2,2] row_mask:0xf bank_mask:0xf
  v_add_f32_dpp v27, v151, v27 quad_perm:[3,3,3,3] row_mask:0xf bank_mask:0xf
  v_cndmask_b32_e64 v24, v24, v27, s[88:89]
  v_cvt_pk_bf16_f32 v24, v24, v24
  v_lshlrev_b32 v24, 16, v24
  v_mul_f32 v24, 0x3d93cd3a, v24
  v_cvt_pk_bf16_f32 v24, v24, v24
  v_lshlrev_b32 v24, 16, v24
  v_mov_b32 v25, v24
  s_nop 1
  v_max_f32_dpp v25, v25, v25 row_shr:1 row_mask:0xf bank_mask:0xf
  s_nop 1
  v_max_f32_dpp v25, v25, v25 row_shr:2 row_mask:0xf bank_mask:0xf
  s_nop 1
  v_max_f32_dpp v25, v25, v25 row_shr:4 row_mask:0xf bank_mask:0xf
  s_nop 1
  v_max_f32_dpp v25, v25, v25 row_shr:8 row_mask:0xf bank_mask:0xf
  s_nop 1
  v_max_f32_dpp v25, v25, v25 row_bcast:15 row_mask:0xa bank_mask:0xf
  s_nop 1
  v_max_f32_dpp v25, v25, v25 row_bcast:31 row_mask:0xc bank_mask:0xf
  s_nop 0
  v_readlane_b32 s37, v25, 63
  s_lshl_b32 s38, s27, 3
  v_mov_b32 v28, s38
  v_mov_b32 v26, s37
  v_mov_b32 v27, s25
  ds_write_b64 v28, v[26:27] offset:64
  v_mov_b32 v41, 0
Lw_125:
  ds_read_b128 v[32:35], v41 offset:64
  ds_read_b128 v[36:39], v41 offset:80
  s_waitcnt lgkmcnt(0)
  v_xor_b32 v40, s25, v33
  v_xor_b32 v41, s25, v35
  v_or_b32 v40, v40, v41
  v_xor_b32 v41, s25, v37
  v_or_b32 v40, v40, v41
  v_xor_b32 v41, s25, v39
  v_or_b32 v40, v40, v41
  v_mov_b32 v41, 0
  v_cmp_ne_u32 vcc, 0, v40
  s_cmp_eq_u64 vcc, 0
  s_cbranch_scc1 Lwd_126
  s_sleep 1
  s_sub_u32 s26, s26, 1
  s_cbranch_scc0 Lw_125
  s_branch L_end
Lwd_126:
  v_max_f32 v32, v32, v34
  v_max3_f32 v32, v32, v36, v38
  v_sub_f32 v24, v24, v32
  v_mul_f32 v24, 0x3fb8aa3b, v24
  v_exp_f32 v24, v24
  s_nop 0
  v_cvt_pk_bf16_f32 v25, v24, v24
  ds_write_b16 v5, v25 offset:640
  s_nop 1
  v_add_f32_dpp v24, v24, v24 row_shr:1 row_mask:0xf bank_mask:0xf
  s_nop 1
  v_add_f32_dpp v24, v24, v24 row_shr:2 row_mask:0xf bank_mask:0xf
  s_nop 1
  v_add_f32_dpp v24, v24, v24 row_shr:4 row_mask:0xf bank_mask:0xf
  s_nop 1
  v_add_f32_dpp v24, v24, v24 row_shr:8 row_mask:0xf bank_mask:0xf
  s_nop 1
  v_add_f32_dpp v24, v24, v24 row_bcast:15 row_mask:0xa bank_mask:0xf
  s_nop 1
  v_add_f32_dpp v24, v24, v24 row_bcast:31 row_mask:0xc bank_mask:0xf
  s_nop 0
  v_readlane_b32 s37, v24, 63
  s_nop 1
  v_mov_b32 v26, s37
  ds_write_b64 v28, v[26:27] offset:96
  s_branch L_end
L_v:
  s_setprio 1
  s_sub_u32 s27, s24, 8
  v_lshrrev_b32 v1, 3, v0
  v_mul_u32_u24 v1, 384, v1
  v_and_b32 v8, 7, v0
  v_lshl_add_u32 v1, v8, 4, v1
  s_mul_i32 s36, s7, 1572864
  s_mul_i32 s37, s5, 98304
  s_add_u32 s36, s36, s37
  s_lshl_b32 s37, s27, 7
  s_add_u32 s36, s36, s37
  s_add_u32 s36, s36, 1179648
  s_mov_b32 s32, s16
  s_and_b32 s33, s17, 0xffff
  s_mov_b32 s34, 50331648
  s_mov_b32 s35, 0x00020000
  s_mov_b32 s28, s22
  s_and_b32 s29, s23, 0xffff
  s_mov_b32 s30, 268435456
  s_mov_b32 s31, 0x00020000
  s_waitcnt lgkmcnt(0)
  s_mul_i32 s25, s25, 0x9E3779B1
  s_add_u32 s25, s25, 0x7F4A7C15
  s_andn2_b32 s25, s25, 15
  s_or_b32 s25, s25, 8
  s_or_b32 s25, s25, s60
  v_mov_b32 v3, s25
  s_add_u32 s56, s27, 1
  s_mul_i32 s56, s56, 24
  s_mov_b32 s57, 0
  v_mov_b32 v24, 0
  v_bfe_u32 v8, v0, 2, 2
  v_bfe_u32 v9, v0, 1, 1
  v_cmp_eq_u32 vcc, 1, v9
  v_mov_b32 v10, 0x0c0c0100
  v_mov_b32 v11, 0x01000c0c
  v_cndmask_b32 v10, v10, v11, vcc
  v_mov_b32 v9, 0x0c0c0302
  v_mov_b32 v11, 0x03020c0c
  v_cndmask_b32 v11, v9, v11, vcc
  v_mov_b32 v9, 0x0c0c0c0c
  v_cmp_eq_u32 vcc, 0, v8
  s_nop 1
  v_cndmask_b32 v16, v9, v10, vcc
  v_cndmask_b32 v17, v9, v11, vcc
  v_cmp_eq_u32 vcc, 1, v8
  s_nop 1
  v_cndmask_b32 v18, v9, v10, vcc
  v_cndmask_b32 v19, v9, v11, vcc
  v_cmp_eq_u32 vcc, 2, v8
  s_nop 1
  v_cndmask_b32 v20, v9, v10, vcc
  v_cndmask_b32 v21, v9, v11, vcc
  v_cmp_eq_u32 vcc, 3, v8
  s_nop 1
  v_cndmask_b32 v22, v9, v10, vcc
  v_cndmask_b32 v23, v9, v11, vcc
  v_lshrrev_b32 v2, 4, v0
  v_and_b32 v8, 1, v0
  v_lshl_add_u32 v2, v2, 1, v8
  v_mul_u32_u24 v2, 64, v2
Lg_159:
  s_cmp_ge_u32 s57, s56
  s_cbranch_scc1 Lgo_160
  ds_read_b128 v[28:31], v24 offset:16
  s_waitcnt lgkmcnt(0)
  v_add3_u32 v28, v28, v29, v30
  v_add_u32 v28, v28, v31
  s_nop 0
  v_readfirstlane_b32 s57, v28
  s_mul_i32 s57, s57, 24
  s_cmp_ge_u32 s57, s56
  s_cbranch_scc1 Lgo_160
  s_sleep 1
  s_sub_u32 s26, s26, 1
  s_cbranch_scc0 Lg_159
  s_branch L_end
Lgo_160:
  s_add_u32 s56, s56, 72
  buffer_load_dwordx4 v[40:43], v1, s[32:35], s36 offen nt
  s_add_u32 s36, s36, 3072
Lg_161:
  s_cmp_ge_u32 s57, s56
  s_cbranch_scc1 Lgo_162
  ds_read_b128 v[28:31], v24 offset:16
  s_waitcnt lgkmcnt(0)
  v_add3_u32 v28, v28, v29, v30
  v_add_u32 v28, v28, v31
  s_nop 0
  v_readfirstlane_b32 s57, v28
  s_mul_i32 s57, s57, 24
  s_cmp_ge_u32 s57, s56
  s_cbranch_scc1 Lgo_162
  s_sleep 1
  s_sub_u32 s26, s26, 1
  s_cbranch_scc0 Lg_161
  s_branch L_end
L_pad10:
  s_branch L_pad13
Lgo_162:
  s_add_u32 s56, s56, 72
  buffer_load_dwordx4 v[44:47], v1, s[32:35], s36 offen nt
  s_add_u32 s36, s36, 3072
Lg_163:
  s_cmp_ge_u32 s57, s56
  s_cbranch_scc1 Lgo_164
  ds_read_b128 v[28:31], v24 offset:16
  s_waitcnt lgkmcnt(0)
  v_add3_u32 v28, v28, v29, v30
  v_add_u32 v28, v28, v31
  s_nop 0
  v_readfirstlane_b32 s57, v28
  s_mul_i32 s57, s57, 24
  s_cmp_ge_u32 s57, s56
  s_cbranch_scc1 Lgo_164
  s_sleep 1
  s_sub_u32 s26, s26, 1
  s_cbranch_scc0 Lg_163
  s_branch L_end
Lgo_164:
  s_add_u32 s56, s56, 72
  buffer_load_dwordx4 v[48:51], v1, s[32:35], s36 offen nt
  s_add_u32 s36, s36, 3072
Lg_165:
  s_cmp_ge_u32 s57, s56
  s_cbranch_scc1 Lgo_166
  ds_read_b128 v[28:31], v24 offset:16
  s_waitcnt lgkmcnt(0)
  v_add3_u32 v28, v28, v29, v30
  v_add_u32 v28, v28, v31
  s_nop 0
  v_readfirstlane_b32 s57, v28
  s_mul_i32 s57, s57, 24
  s_cmp_ge_u32 s57, s56
  s_cbranch_scc1 Lgo_166
  s_sleep 1
  s_sub_u32 s26, s26, 1
  s_cbranch_scc0 Lg_165
  s_branch L_end
Lgo_166:
  s_add_u32 s56, s56, 72
  buffer_load_dwordx4 v[52:55], v1, s[32:35], s36 offen nt
  s_add_u32 s36, s36, 3072
Lg_167:
  s_cmp_ge_u32 s57, s56
  s_cbranch_scc1 Lgo_168
  ds_read_b128 v[28:31], v24 offset:16
  s_waitcnt lgkmcnt(0)
  v_add3_u32 v28, v28, v29, v30
  v_add_u32 v28, v28, v31
  s_nop 0
  v_readfirstlane_b32 s57, v28
  s_mul_i32 s57, s57, 24
  s_cmp_ge_u32 s57, s56
  s_cbranch_scc1 Lgo_168
  s_sleep 1
  s_sub_u32 s26, s26, 1
  s_cbranch_scc0 Lg_167
  s_branch L_end
Lgo_168:
  s_add_u32 s56, s56, 72
  buffer_load_dwordx4 v[56:59], v1, s[32:35], s36 offen nt
  s_add_u32 s36, s36, 3072
Lg_169:
  s_cmp_ge_u32 s57, s56
  s_cbranch_scc1 Lgo_170
  ds_read_b128 v[28:31], v24 offset:16
  s_waitcnt lgkmcnt(0)
  v_add3_u32 v28, v28, v29, v30
  v_add_u32 v28, v28, v31
  s_nop 0
  v_readfirstlane_b32 s57, v28
  s_mul_i32 s57, s57, 24
  s_cmp_ge_u32 s57, s56
  s_cbranch_scc1 Lgo_170
  s_sleep 1
  s_sub_u32 s26, s26, 1
  s_cbranch_scc0 Lg_169
  s_branch L_end
Lgo_170:
  s_add_u32 s56, s56, 72
  buffer_load_dwordx4 v[60:63], v1, s[32:35], s36 offen nt
  s_add_u32 s36, s36, 3072
Lg_171:
  s_cmp_ge_u32 s57, s56
  s_cbranch_scc1 Lgo_172
  ds_read_b128 v[28:31], v24 offset:16
  s_waitcnt lgkmcnt(0)
  v_add3_u32 v28, v28, v29, v30
  v_add_u32 v28, v28, v31
  s_nop 0
  v_readfirstlane_b32 s57, v28
  s_mul_i32 s57, s57, 24
  s_cmp_ge_u32 s57, s56
  s_cbranch_scc1 Lgo_172
  s_sleep 1
  s_sub_u32 s26, s26, 1
  s_cbranch_scc0 Lg_171
  s_branch L_end
Lgo_172:
  s_add_u32 s56, s56, 72
  buffer_load_dwordx4 v[64:67], v1, s[32:35], s36 offen nt
  s_add_u32 s36, s36, 3072
Lg_173:
  s_cmp_ge_u32 s57, s56
  s_cbranch_scc1 Lgo_174
  ds_read_b128 v[28:31], v24 offset:16
  s_waitcnt lgkmcnt(0)
  v_add3_u32 v28, v28, v29, v30
  v_add_u32 v28, v28, v31
  s_nop 0
  v_readfirstlane_b32 s57, v28
  s_mul_i32 s57, s57, 24
  s_cmp_ge_u32 s57, s56
  s_cbranch_scc1 Lgo_174
  s_sleep 1
  s_sub_u32 s26, s26, 1
  s_cbranch_scc0 Lg_173
  s_branch L_end
Lgo_174:
  s_add_u32 s56, s56, 72
  buffer_load_dwordx4 v[68:71], v1, s[32:35], s36 offen nt
  s_add_u32 s36, s36, 3072
  ds_read_b32 v28, v24 offset:144
  s_waitcnt lgkmcnt(0)
  v_cmp_ne_u32 vcc, 0, v28
  s_cbranch_vccnz Lvb_135
  s_waitcnt vmcnt(7)
  buffer_load_dwordx4 v[72:75], v1, s[32:35], s36 offen nt
  s_add_u32 s36, s36, 3072
  ds_read_b32 v28, v24 offset:144
  s_waitcnt lgkmcnt(0)
  v_cmp_ne_u32 vcc, 0, v28
  s_cbranch_vccnz Lvb_136
  s_waitcnt vmcnt(7)
  buffer_load_dwordx4 v[76:79], v1, s[32:35], s36 offen nt
  s_add_u32 s36, s36, 3072
  ds_read_b32 v28, v24 offset:144
  s_waitcnt lgkmcnt(0)
  v_cmp_ne_u32 vcc, 0, v28
  s_cbranch_vccnz Lvb_137
  s_waitcnt vmcnt(7)
  buffer_load_dwordx4 v[80:83], v1, s[32:35], s36 offen nt
  s_add_u32 s36, s36, 3072
  ds_read_b32 v28, v24 offset:144
  s_waitcnt lgkmcnt(0)
  v_cmp_ne_u32 vcc, 0, v28
  s_cbranch_vccnz Lvb_138
  s_waitcnt vmcnt(7)
  buffer_load_dwordx4 v[84:87], v1, s[32:35], s36 offen nt
  s_add_u32 s36, s36, 3072
  ds_read_b32 v28, v24 offset:144
  s_waitcnt lgkmcnt(0)
  v_cmp_ne_u32 vcc, 0, v28
  s_cbranch_vccnz Lvb_139
  s_waitcnt vmcnt(7)
  buffer_load_dwordx4 v[88:91], v1, s[32:35], s36 offen nt
  s_add_u32 s36, s36, 3072
  ds_read_b32 v28, v24 offset:144
  s_waitcnt lgkmcnt(0)
  v_cmp_ne_u32 vcc, 0, v28
  s_cbranch_vccnz Lvb_140
  s_waitcnt vmcnt(7)
  buffer_load_dwordx4 v[92:95], v1, s[32:35], s36 offen nt
  s_add_u32 s36, s36, 3072
  ds_read_b32 v28, v24 offset:144
  s_waitcnt lgkmcnt(0)
  v_cmp_ne_u32 vcc, 0, v28
  s_cbranch_vccnz Lvb_141
  s_waitcnt vmcnt(7)
  buffer_load_dwordx4 v[96:99], v1, s[32:35], s36 offen nt
  s_add_u32 s36, s36, 3072
  ds_read_b32 v28, v24 offset:144
  s_waitcnt lgkmcnt(0)
  v_cmp_ne_u32 vcc, 0, v28
  s_cbranch_vccnz Lvb_142
  s_waitcnt vmcnt(7)
  buffer_load_dwordx4 v[100:103], v1, s[32:35], s36 offen nt
  s_add_u32 s36, s36, 3072
  ds_read_b32 v28, v24 offset:144
  s_waitcnt lgkmcnt(0)
  v_cmp_ne_u32 vcc, 0, v28
  s_cbranch_vccnz Lvb_143
  s_waitcnt vmcnt(7)
  buffer_load_dwordx4 v[104:107], v1, s[32:35], s36 offen nt
  s_add_u32 s36, s36, 3072
  ds_read_b32 v28, v24 offset:144
  s_waitcnt lgkmcnt(0)
  v_cmp_ne_u32 vcc, 0, v28
  s_cbranch_vccnz Lvb_144
  s_waitcnt vmcnt(7)
  buffer_load_dwordx4 v[108:111], v1, s[32:35], s36 offen nt
  s_add_u32 s36, s36, 3072
  s_branch L_pad11_x
L_pad11:
  s_branch L_pad14
L_pad11_x:
  ds_read_b32 v28, v24 offset:144
  s_waitcnt lgkmcnt(0)
  v_cmp_ne_u32 vcc, 0, v28
  s_cbranch_vccnz Lvb_145
  s_waitcnt vmcnt(7)
  buffer_load_dwordx4 v[112:115], v1, s[32:35], s36 offen nt
  s_add_u32 s36, s36, 3072
  ds_read_b32 v28, v24 offset:144
  s_waitcnt lgkmcnt(0)
  v_cmp_ne_u32 vcc, 0, v28
  s_cbranch_vccnz Lvb_146
  s_waitcnt vmcnt(7)
  buffer_load_dwordx4 v[116:119], v1, s[32:35], s36 offen nt
  s_add_u32 s36, s36, 3072
  ds_read_b32 v28, v24 offset:144
  s_waitcnt lgkmcnt(0)
  v_cmp_ne_u32 vcc, 0, v28
  s_cbranch_vccnz Lvb_147
  s_waitcnt vmcnt(7)
  buffer_load_dwordx4 v[120:123], v1, s[32:35], s36 offen nt
  s_add_u32 s36, s36, 3072
  ds_read_b32 v28, v24 offset:144
  s_waitcnt lgkmcnt(0)
  v_cmp_ne_u32 vcc, 0, v28
  s_cbranch_vccnz Lvb_148
  s_waitcnt vmcnt(7)
  buffer_load_dwordx4 v[124:127], v1, s[32:35], s36 offen nt
  s_add_u32 s36, s36, 3072
  ds_read_b32 v28, v24 offset:144
  s_waitcnt lgkmcnt(0)
  v_cmp_ne_u32 vcc, 0, v28
  s_cbranch_vccnz Lvb_149
  s_waitcnt vmcnt(7)
  s_branch L_pad12_x
L_pad12:
  s_branch L_pad15
L_pad12_x:
  buffer_load_dwordx4 v[128:131], v1, s[32:35], s36 offen nt
  s_add_u32 s36, s36, 3072
  ds_read_b32 v28, v24 offset:144
  s_waitcnt lgkmcnt(0)
  v_cmp_ne_u32 vcc, 0, v28
  s_cbranch_vccnz Lvb_150
  s_waitcnt vmcnt(7)
  buffer_load_dwordx4 v[132:135], v1, s[32:35], s36 offen nt
  s_add_u32 s36, s36, 3072
  ds_read_b32 v28, v24 offset:144
  s_waitcnt lgkmcnt(0)
  v_cmp_ne_u32 vcc, 0, v28
  s_cbranch_vccnz Lvb_151
  s_waitcnt vmcnt(7)
  buffer_load_dwordx4 v[136:139], v1, s[32:35], s36 offen nt
  s_add_u32 s36, s36, 3072
  ds_read_b32 v28, v24 offset:144
  s_waitcnt lgkmcnt(0)
  v_cmp_ne_u32 vcc, 0, v28
  s_cbranch_vccnz Lvb_152
  s_waitcnt vmcnt(7)
  buffer_load_dwordx4 v[140:143], v1, s[32:35], s36 offen nt
  s_add_u32 s36, s36, 3072
  ds_read_b32 v28, v24 offset:144
  s_waitcnt lgkmcnt(0)
  v_cmp_ne_u32 vcc, 0, v28
  s_cbranch_vccnz Lvb_153
  s_waitcnt vmcnt(7)
  buffer_load_dwordx4 v[144:147], v1, s[32:35], s36 offen nt
  s_add_u32 s36, s36, 3072
  ds_read_b32 v28, v24 offset:144
  s_waitcnt lgkmcnt(0)
  v_cmp_ne_u32 vcc, 0, v28
  s_cbranch_vccnz Lvb_154
  s_waitcnt vmcnt(7)
  buffer_load_dwordx4 v[148:151], v1, s[32:35], s36 offen nt
  s_add_u32 s36, s36, 3072
  ds_read_b32 v28, v24 offset:144
  s_waitcnt lgkmcnt(0)
  v_cmp_ne_u32 vcc, 0, v28
  s_cbranch_vccnz Lvb_155
  s_waitcnt vmcnt(7)
  buffer_load_dwordx4 v[152:155], v1, s[32:35], s36 offen nt
  s_add_u32 s36, s36, 3072
  ds_read_b32 v28, v24 offset:144
  s_waitcnt lgkmcnt(0)
  v_cmp_ne_u32 vcc, 0, v28
  s_cbranch_vccnz Lvb_156
  s_waitcnt vmcnt(7)
  buffer_load_dwordx4 v[156:159], v1, s[32:35], s36 offen nt
  s_add_u32 s36, s36, 3072
  ds_read_b32 v28, v24 offset:144
  s_waitcnt lgkmcnt(0)
  v_cmp_ne_u32 vcc, 0, v28
  s_cbranch_vccnz Lvb_157
  s_waitcnt vmcnt(7)
  buffer_load_dwordx4 v[160:163], v1, s[32:35], s36 offen nt
  s_add_u32 s36, s36, 3072
  ds_read_b32 v28, v24 offset:144
  s_waitcnt lgkmcnt(0)
  v_cmp_ne_u32 vcc, 0, v28
  s_cbranch_vccnz Lvb_158
  s_waitcnt vmcnt(7)
  buffer_load_dwordx4 v[164:167], v1, s[32:35], s36 offen nt
  s_add_u32 s36, s36, 3072
  s_branch L_vb_j
Lvb_135:
  buffer_load_dwordx4 v[72:75], v1, s[32:35], s36 offen nt
  s_add_u32 s36, s36, 3072
Lvb_136:
  buffer_load_dwordx4 v[76:79], v1, s[32:35], s36 offen nt
  s_add_u32 s36, s36, 3072
Lvb_137:
  buffer_load_dwordx4 v[80:83], v1, s[32:35], s36 offen nt
  s_add_u32 s36, s36, 3072
Lvb_138:
  buffer_load_dwordx4 v[84:87], v1, s[32:35], s36 offen nt
  s_add_u32 s36, s36, 3072
Lvb_139:
  buffer_load_dwordx4 v[88:91], v1, s[32:35], s36 offen nt
  s_add_u32 s36, s36, 3072
Lvb_140:
  buffer_load_dwordx4 v[92:95], v1, s[32:35], s36 offen nt
  s_add_u32 s36, s36, 3072
  s_waitcnt vmcnt(13)
Lvb_141:
  buffer_load_dwordx4 v[96:99], v1, s[32:35], s36 offen nt
  s_add_u32 s36, s36, 3072
  s_waitcnt vmcnt(13)
Lvb_142:
  buffer_load_dwordx4 v[100:103], v1, s[32:35], s36 offen nt
  s_add_u32 s36, s36, 3072
  s_waitcnt vmcnt(13)
Lvb_143:
  buffer_load_dwordx4 v[104:107], v1, s[32:35], s36 offen nt
  s_add_u32 s36, s36, 3072
  s_waitcnt vmcnt(13)
Lvb_144:
  buffer_load_dwordx4 v[108:111], v1, s[32:35], s36 offen nt
  s_add_u32 s36, s36, 3072
  s_waitcnt vmcnt(13)
Lvb_145:
  buffer_load_dwordx4 v[112:115], v1, s[32:35], s36 offen nt
  s_add_u32 s36, s36, 3072
  s_waitcnt vmcnt(13)
Lvb_146:
  buffer_load_dwordx4 v[116:119], v1, s[32:35], s36 offen nt
  s_add_u32 s36, s36, 3072
  s_waitcnt vmcnt(13)
Lvb_147:
  buffer_load_dwordx4 v[120:123], v1, s[32:35], s36 offen nt
  s_add_u32 s36, s36, 3072
  s_waitcnt vmcnt(13)
Lvb_148:
  buffer_load_dwordx4 v[124:127], v1, s[32:35], s36 offen nt
  s_add_u32 s36, s36, 3072
  s_waitcnt vmcnt(13)
Lvb_149:
  buffer_load_dwordx4 v[128:131], v1, s[32:35], s36 offen nt
  s_add_u32 s36, s36, 3072
  s_waitcnt vmcnt(13)
Lvb_150:
  buffer_load_dwordx4 v[132:135], v1, s[32:35], s36 offen nt
  s_add_u32 s36, s36, 3072
  s_waitcnt vmcnt(13)
Lvb_151:
  buffer_load_dwordx4 v[136:139], v1, s[32:35], s36 offen nt
  s_add_u32 s36, s36, 3072
  s_waitcnt vmcnt(13)
Lvb_152:
  buffer_load_dwordx4 v[140:143], v1, s[32:35], s36 offen nt
  s_add_u32 s36, s36, 3072
  s_waitcnt vmcnt(13)
Lvb_153:
  buffer_load_dwordx4 v[144:147], v1, s[32:35], s36 offen nt
  s_add_u32 s36, s36, 3072
  s_waitcnt vmcnt(13)
Lvb_154:
  buffer_load_dwordx4 v[148:151], v1, s[32:35], s36 offen nt
  s_add_u32 s36, s36, 3072
  s_waitcnt vmcnt(13)
Lvb_155:
  buffer_load_dwordx4 v[152:155], v1, s[32:35], s36 offen nt
  s_add_u32 s36, s36, 3072
  s_waitcnt vmcnt(13)
Lvb_156:
  buffer_load_dwordx4 v[156:159], v1, s[32:35], s36 offen nt
  s_add_u32 s36, s36, 3072
  s_waitcnt vmcnt(13)
Lvb_157:
  buffer_load_dwordx4 v[160:163], v1, s[32:35], s36 offen nt
  s_add_u32 s36, s36, 3072
  s_waitcnt vmcnt(13)
Lvb_158:
  buffer_load_dwordx4 v[164:167], v1, s[32:35], s36 offen nt
  s_add_u32 s36, s36, 3072
L_vb_j:
  s_setprio 3
  s_lshl_b32 s37, s27, 2
  v_mov_b32 v1, s37
  v_mov_b32 v33, 0
  ds_read_b128 v[24:27], v33 offset:96
  ds_read_b128 v[28:31], v33 offset:112
  s_waitcnt lgkmcnt(0)
  v_xor_b32 v25, s25, v25
  v_xor_b32 v27, s25, v27
  v_xor_b32 v29, s25, v29
  v_xor_b32 v31, s25, v31
  v_or3_b32 v25, v25, v27, v29
  v_or_b32 v25, v25, v31
  v_cmp_ne_u32 vcc, 0, v25
  s_cmp_eq_u64 vcc, 0
  s_cbranch_scc1 L_v_fast
  s_waitcnt vmcnt(7)
  v_mov_b32 v24, 1
  ds_write_b32 v1, v24 offset:32
  s_waitcnt vmcnt(6)
  v_mov_b32 v24, 2
  ds_write_b32 v1, v24 offset:32
  s_waitcnt vmcnt(5)
  v_mov_b32 v24, 3
  ds_write_b32 v1, v24 offset:32
  s_waitcnt vmcnt(4)
  v_mov_b32 v24, 4
  ds_write_b32 v1, v24 offset:32
  s_waitcnt vmcnt(3)
  v_mov_b32 v24, 5
  ds_write_b32 v1, v24 offset:32
  s_waitcnt vmcnt(2)
  v_mov_b32 v24, 6
  ds_write_b32 v1, v24 offset:32
  s_waitcnt vmcnt(1)
  v_mov_b32 v24, 7
  s_branch L_pad13_x
L_pad13:
  s_branch L_pdone
L_pad13_x:
  ds_write_b32 v1, v24 offset:32
  s_waitcnt vmcnt(0)
  v_mov_b32 v24, 8
  ds_write_b32 v1, v24 offset:32
  v_mov_b32 v33, 0
Lw_175:
  ds_read_b128 v[24:27], v33 offset:96
  ds_read_b128 v[28:31], v33 offset:112
  s_waitcnt lgkmcnt(0)
  v_xor_b32 v32, s25, v25
  v_xor_b32 v33, s25, v27
  v_or_b32 v32, v32, v33
  v_xor_b32 v33, s25, v29
  v_or_b32 v32, v32, v33
  v_xor_b32 v33, s25, v31
  v_or_b32 v32, v32, v33
  v_mov_b32 v33, 0
  v_cmp_ne_u32 vcc, 0, v32
  s_cmp_eq_u64 vcc, 0
  s_cbranch_scc1 Lwd_176
  s_sleep 1
  s_sub_u32 s26, s26, 1
  s_cbranch_scc0 Lw_175
  s_branch L_end
Lwd_176:
  s_mov_b32 s56, 1
  s_branch L_v_go
L_v_fast:
  s_mov_b32 s56, 0
L_v_go:
  ds_read_b128 v[24:27], v2 offset:640
  ds_read_b128 v[28:31], v2 offset:656
  ds_read_b128 v[32:35], v2 offset:672
  ds_read_b128 v[36:39], v2 offset:688
  v_mov_b32 v8, 0
  ds_read_b32 v9, v8 offset:148
  s_waitcnt lgkmcnt(0)
  v_readfirstlane_b32 s58, v9
  v_perm_b32 v8, v24, v24, v16
  v_perm_b32 v9, v24, v24, v18
  v_perm_b32 v10, v24, v24, v20
  v_perm_b32 v11, v24, v24, v22
  v_perm_b32 v12, v24, v24, v17
  v_perm_b32 v13, v24, v24, v19
  v_perm_b32 v14, v24, v24, v21
  v_perm_b32 v15, v24, v24, v23
  s_waitcnt vmcnt(31)
  v_mfma_f32_16x16x32_bf16 v[4:7], v[8:11], v[40:43], 0
  v_perm_b32 v8, v25, v25, v16
  v_perm_b32 v9, v25, v25, v18
  v_perm_b32 v10, v25, v25, v20
  v_perm_b32 v11, v25, v25, v22
  s_waitcnt vmcnt(30)
  v_mfma_f32_16x16x32_bf16 v[4:7], v[12:15], v[44:47], v[4:7]
  v_perm_b32 v12, v25, v25, v17
  v_perm_b32 v13, v25, v25, v19
  v_perm_b32 v14, v25, v25, v21
  v_perm_b32 v15, v25, v25, v23
  s_waitcnt vmcnt(29)
  v_mfma_f32_16x16x32_bf16 v[4:7], v[8:11], v[48:51], v[4:7]
  v_perm_b32 v8, v26, v26, v16
  v_perm_b32 v9, v26, v26, v18
  v_perm_b32 v10, v26, v26, v20
  v_perm_b32 v11, v26, v26, v22
  s_waitcnt vmcnt(28)
  v_mfma_f32_16x16x32_bf16 v[4:7], v[12:15], v[52:55], v[4:7]
  v_perm_b32 v12, v26, v26, v17
  v_perm_b32 v13, v26, v26, v19
  v_perm_b32 v14, v26, v26, v21
  v_perm_b32 v15, v26, v26, v23
  s_waitcnt vmcnt(27)
  v_mfma_f32_16x16x32_bf16 v[4:7], v[8:11], v[56:59], v[4:7]
  v_perm_b32 v8, v27, v27, v16
  v_perm_b32 v9, v27, v27, v18
  v_perm_b32 v10, v27, v27, v20
  v_perm_b32 v11, v27, v27, v22
  s_waitcnt vmcnt(26)
  v_mfma_f32_16x16x32_bf16 v[4:7], v[12:15], v[60:63], v[4:7]
  v_perm_b32 v12, v27, v27, v17
  v_perm_b32 v13, v27, v27, v19
  v_perm_b32 v14, v27, v27, v21
  v_perm_b32 v15, v27, v27, v23
  s_waitcnt vmcnt(25)
  v_mfma_f32_16x16x32_bf16 v[4:7], v[8:11], v[64:67], v[4:7]
  v_perm_b32 v8, v28, v28, v16
  v_perm_b32 v9, v28, v28, v18
  v_perm_b32 v10, v28, v28, v20
  v_perm_b32 v11, v28, v28, v22
  s_waitcnt vmcnt(24)
  v_mfma_f32_16x16x32_bf16 v[4:7], v[12:15], v[68:71], v[4:7]
  v_perm_b32 v12, v28, v28, v17
  v_perm_b32 v13, v28, v28, v19
  v_perm_b32 v14, v28, v28, v21
  v_perm_b32 v15, v28, v28, v23
  s_waitcnt vmcnt(23)
  v_mfma_f32_16x16x32_bf16 v[4:7], v[8:11], v[72:75], v[4:7]
  v_perm_b32 v8, v29, v29, v16
  v_perm_b32 v9, v29, v29, v18
  v_perm_b32 v10, v29, v29, v20
  v_perm_b32 v11, v29, v29, v22
  s_waitcnt vmcnt(22)
  v_mfma_f32_16x16x32_bf16 v[4:7], v[12:15], v[76:79], v[4:7]
  v_perm_b32 v12, v29, v29, v17
  v_perm_b32 v13, v29, v29, v19
  v_perm_b32 v14, v29, v29, v21
  v_perm_b32 v15, v29, v29, v23
  s_waitcnt vmcnt(21)
  v_mfma_f32_16x16x32_bf16 v[4:7], v[8:11], v[80:83], v[4:7]
  v_perm_b32 v8, v30, v30, v16
  v_perm_b32 v9, v30, v30, v18
  v_perm_b32 v10, v30, v30, v20
  v_perm_b32 v11, v30, v30, v22
  s_waitcnt vmcnt(20)
  v_mfma_f32_16x16x32_bf16 v[4:7], v[12:15], v[84:87], v[4:7]
  v_perm_b32 v12, v30, v30, v17
  v_perm_b32 v13, v30, v30, v19
  v_perm_b32 v14, v30, v30, v21
  v_perm_b32 v15, v30, v30, v23
  s_waitcnt vmcnt(19)
  v_mfma_f32_16x16x32_bf16 v[4:7], v[8:11], v[88:91], v[4:7]
  v_perm_b32 v8, v31, v31, v16
  v_perm_b32 v9, v31, v31, v18
  v_perm_b32 v10, v31, v31, v20
  v_perm_b32 v11, v31, v31, v22
  s_waitcnt vmcnt(18)
  v_mfma_f32_16x16x32_bf16 v[4:7], v[12:15], v[92:95], v[4:7]
  v_perm_b32 v12, v31, v31, v17
  v_perm_b32 v13, v31, v31, v19
  v_perm_b32 v14, v31, v31, v21
  v_perm_b32 v15, v31, v31, v23
  s_waitcnt vmcnt(17)
  v_mfma_f32_16x16x32_bf16 v[4:7], v[8:11], v[96:99], v[4:7]
  v_perm_b32 v8, v32, v32, v16
  v_perm_b32 v9, v32, v32, v18
  v_perm_b32 v10, v32, v32, v20
  v_perm_b32 v11, v32, v32, v22
  s_waitcnt vmcnt(16)
  v_mfma_f32_16x16x32_bf16 v[4:7], v[12:15], v[100:103], v[4:7]
  v_perm_b32 v12, v32, v32, v17
  v_perm_b32 v13, v32, v32, v19
  v_perm_b32 v14, v32, v32, v21
  v_perm_b32 v15, v32, v32, v23
  s_waitcnt vmcnt(15)
  v_mfma_f32_16x16x32_bf16 v[4:7], v[8:11], v[104:107], v[4:7]
  v_perm_b32 v8, v33, v33, v16
  v_perm_b32 v9, v33, v33, v18
  v_perm_b32 v10, v33, v33, v20
  v_perm_b32 v11, v33, v33, v22
  s_waitcnt vmcnt(14)
  v_mfma_f32_16x16x32_bf16 v[4:7], v[12:15], v[108:111], v[4:7]
  v_perm_b32 v12, v33, v33, v17
  v_perm_b32 v13, v33, v33, v19
  v_perm_b32 v14, v33, v33, v21
  s_branch L_pad14_x
L_pad14:
  s_branch L_pdone
L_pad14_x:
  v_perm_b32 v15, v33, v33, v23
  s_waitcnt vmcnt(13)
  v_mfma_f32_16x16x32_bf16 v[4:7], v[8:11], v[112:115], v[4:7]
  v_perm_b32 v8, v34, v34, v16
  v_perm_b32 v9, v34, v34, v18
  v_perm_b32 v10, v34, v34, v20
  v_perm_b32 v11, v34, v34, v22
  s_waitcnt vmcnt(12)
  v_mfma_f32_16x16x32_bf16 v[4:7], v[12:15], v[116:119], v[4:7]
  v_perm_b32 v12, v34, v34, v17
  v_perm_b32 v13, v34, v34, v19
  v_perm_b32 v14, v34, v34, v21
  v_perm_b32 v15, v34, v34, v23
  s_waitcnt vmcnt(11)
  v_mfma_f32_16x16x32_bf16 v[4:7], v[8:11], v[120:123], v[4:7]
  v_perm_b32 v8, v35, v35, v16
  v_perm_b32 v9, v35, v35, v18
  v_perm_b32 v10, v35, v35, v20
  v_perm_b32 v11, v35, v35, v22
  s_waitcnt vmcnt(10)
  v_mfma_f32_16x16x32_bf16 v[4:7], v[12:15], v[124:127], v[4:7]
  v_perm_b32 v12, v35, v35, v17
  v_perm_b32 v13, v35, v35, v19
  v_perm_b32 v14, v35, v35, v21
  v_perm_b32 v15, v35, v35, v23
  s_waitcnt vmcnt(9)
  v_mfma_f32_16x16x32_bf16 v[4:7], v[8:11], v[128:131], v[4:7]
  v_perm_b32 v8, v36, v36, v16
  v_perm_b32 v9, v36, v36, v18
  v_perm_b32 v10, v36, v36, v20
  v_perm_b32 v11, v36, v36, v22
  s_waitcnt vmcnt(8)
  v_mfma_f32_16x16x32_bf16 v[4:7], v[12:15], v[132:135], v[4:7]
  v_perm_b32 v12, v36, v36, v17
  v_perm_b32 v13, v36, v36, v19
  v_perm_b32 v14, v36, v36, v21
  v_perm_b32 v15, v36, v36, v23
  s_waitcnt vmcnt(7)
  v_mov_b32 v2, 1
  ds_write_b32 v1, v2 offset:32
  v_mfma_f32_16x16x32_bf16 v[4:7], v[8:11], v[136:139], v[4:7]
  v_perm_b32 v8, v37, v37, v16
  v_perm_b32 v9, v37, v37, v18
  v_perm_b32 v10, v37, v37, v20
  v_perm_b32 v11, v37, v37, v22
  s_waitcnt vmcnt(6)
  v_mov_b32 v2, 2
  ds_write_b32 v1, v2 offset:32
  v_mfma_f32_16x16x32_bf16 v[4:7], v[12:15], v[140:143], v[4:7]
  v_perm_b32 v12, v37, v37, v17
  v_perm_b32 v13, v37, v37, v19
  v_perm_b32 v14, v37, v37, v21
  v_perm_b32 v15, v37, v37, v23
  s_waitcnt vmcnt(5)
  v_mov_b32 v2, 3
  ds_write_b32 v1, v2 offset:32
  v_mfma_f32_16x16x32_bf16 v[4:7], v[8:11], v[144:147], v[4:7]
  v_perm_b32 v8, v38, v38, v16
  v_perm_b32 v9, v38, v38, v18
  v_perm_b32 v10, v38, v38, v20
  v_perm_b32 v11, v38, v38, v22
  s_waitcnt vmcnt(4)
  v_mov_b32 v2, 4
  ds_write_b32 v1, v2 offset:32
  v_mfma_f32_16x16x32_bf16 v[4:7], v[12:15], v[148:151], v[4:7]
  v_perm_b32 v12, v38, v38, v17
  v_perm_b32 v13, v38, v38, v19
  v_perm_b32 v14, v38, v38, v21
  v_perm_b32 v15, v38, v38, v23
  s_waitcnt vmcnt(3)
  v_mov_b32 v2, 5
  ds_write_b32 v1, v2 offset:32
  v_mfma_f32_16x16x32_bf16 v[4:7], v[8:11], v[152:155], v[4:7]
  v_perm_b32 v8, v39, v39, v16
  v_perm_b32 v9, v39, v39, v18
  v_perm_b32 v10, v39, v39, v20
  v_perm_b32 v11, v39, v39, v22
  s_waitcnt vmcnt(2)
  v_mov_b32 v2, 6
  ds_write_b32 v1, v2 offset:32
  v_mfma_f32_16x16x32_bf16 v[4:7], v[12:15], v[156:159], v[4:7]
  v_perm_b32 v12, v39, v39, v17
  v_perm_b32 v13, v39, v39, v19
  v_perm_b32 v14, v39, v39, v21
  v_perm_b32 v15, v39, v39, v23
  s_waitcnt vmcnt(1)
  v_mov_b32 v2, 7
  ds_write_b32 v1, v2 offset:32
  v_mfma_f32_16x16x32_bf16 v[4:7], v[8:11], v[160:163], v[4:7]
  s_nop 1
  s_waitcnt vmcnt(0)
  v_mov_b32 v2, 8
  ds_write_b32 v1, v2 offset:32
  v_mfma_f32_16x16x32_bf16 v[4:7], v[12:15], v[164:167], v[4:7]
  s_nop 7
  v_add_f32_dpp v40, v5, v4 row_ror:8 row_mask:0xf bank_mask:0xf
  v_add_f32_dpp v41, v7, v6 row_ror:8 row_mask:0xf bank_mask:0xf
  v_mov_b32 v42, 0
  v_mov_b32 v43, 0
  s_nop 1
  v_permlane16_swap_b32 v40, v42
  v_permlane16_swap_b32 v41, v43
  s_nop 1
  v_perm_b32 v40, v40, v3, s40
  v_perm_b32 v41, v41, v3, s41
  v_perm_b32 v42, v42, v3, s42
  v_perm_b32 v43, v43, v3, s43
  v_and_b32 v48, 7, v0
  v_lshrrev_b32 v49, 5, v0
  v_lshl_add_u32 v48, v48, 1, v49
  v_lshlrev_b32 v48, 4, v48
  s_mul_i32 s36, s4, 3072
  s_lshl_b32 s37, s27, 10
  s_add_u32 s36, s36, s37
  s_add_u32 s36, s36, 262144
  s_lshl_b32 s39, s5, 8
  s_add_u32 s39, s39, s36
  s_cmp_lg_u32 s58, 0
  s_cbranch_scc1 Ls_177
  s_mov_b32 exec_lo, 0xff
  s_mov_b32 exec_hi, 0xff
  buffer_store_dwordx4 v[40:43], v48, s[28:31], s39 offen
  s_mov_b64 exec, -1
  s_branch Ls_178
Ls_177:
  s_mov_b32 exec_lo, 0xff
  s_mov_b32 exec_hi, 0xff
  buffer_store_dwordx4 v[40:43], v48, s[28:31], s39 offen sc1
  s_mov_b64 exec, -1
Ls_178:
  v_and_b32 v50, 3, v0
  v_lshrrev_b32 v51, 2, v0
  v_lshlrev_b32 v52, 4, v51
  v_lshl_add_u32 v52, v50, 8, v52
  v_mov_b32 v58, 0
Lw_179:
  ds_read_b32 v56, v58 offset:144
  s_waitcnt lgkmcnt(0)
  v_xor_b32 v57, s25, v56
  v_mov_b32 v58, 0
  v_cmp_ne_u32 vcc, 0, v57
  s_cmp_eq_u64 vcc, 0
  s_cbranch_scc1 Lwd_180
  s_sleep 1
  s_sub_u32 s26, s26, 1
  s_cbranch_scc0 Lw_179
  s_branch L_end
L_pad15:
  s_branch L_pdone
Lwd_180:
  v_lshlrev_b32 v53, 2, v50
  ds_read_b32 v53, v53 offset:128
  buffer_load_dwordx4 v[68:71], v52, s[28:31], s36 offen sc1 nt
  s_sleep 10
  buffer_load_dwordx4 v[72:75], v52, s[28:31], s36 offen sc1 nt
  s_sleep 10
Lp_181:
  buffer_load_dwordx4 v[76:79], v52, s[28:31], s36 offen sc1 nt
  s_waitcnt vmcnt(2)
  v_perm_b32 v64, v69, v68, s44
  v_perm_b32 v65, v71, v70, s45
  v_or_b32 v64, v64, v65
  v_xor_b32 v64, s25, v64
  v_cmp_lt_u32 vcc, 7, v64
  s_cmp_eq_u64 vcc, 0
  s_cbranch_scc1 Lpf_183
  buffer_load_dwordx4 v[68:71], v52, s[28:31], s36 offen sc1 nt
  s_waitcnt vmcnt(2)
  v_perm_b32 v64, v73, v72, s44
  v_perm_b32 v65, v75, v74, s45
  v_or_b32 v64, v64, v65
  v_xor_b32 v64, s25, v64
  v_cmp_lt_u32 vcc, 7, v64
  s_cmp_eq_u64 vcc, 0
  s_cbranch_scc1 Lpf_184
  buffer_load_dwordx4 v[72:75], v52, s[28:31], s36 offen sc1 nt
  s_waitcnt vmcnt(2)
  v_perm_b32 v64, v77, v76, s44
  v_perm_b32 v65, v79, v78, s45
  v_or_b32 v64, v64, v65
  v_xor_b32 v64, s25, v64
  v_cmp_lt_u32 vcc, 7, v64
  s_cmp_eq_u64 vcc, 0
  s_cbranch_scc1 Lpf_185
  s_sub_u32 s26, s26, 1
  s_cbranch_scc0 Lp_181
  s_branch L_end
Lpf_183:
  v_mov_b32 v60, v68
  v_mov_b32 v61, v69
  v_mov_b32 v62, v70
  v_mov_b32 v63, v71
  s_branch Lpd_182
Lpf_184:
  v_mov_b32 v60, v72
  v_mov_b32 v61, v73
  v_mov_b32 v62, v74
  v_mov_b32 v63, v75
  s_branch Lpd_182
Lpf_185:
  v_mov_b32 v60, v76
  v_mov_b32 v61, v77
  v_mov_b32 v62, v78
  v_mov_b32 v63, v79
Lpd_182:
  s_nop 1
  s_waitcnt lgkmcnt(0)
  v_mul_f32 v60, v60, v53
  v_mul_f32 v61, v61, v53
  v_mul_f32 v62, v62, v53
  v_mul_f32 v63, v63, v53
  v_add_f32_dpp v64, v60, v60 quad_perm:[1,0,3,2] row_mask:0xf bank_mask:0xf
  v_add_f32_dpp v65, v61, v61 quad_perm:[1,0,3,2] row_mask:0xf bank_mask:0xf
  v_add_f32_dpp v66, v62, v62 quad_perm:[1,0,3,2] row_mask:0xf bank_mask:0xf
  v_add_f32_dpp v67, v63, v63 quad_perm:[1,0,3,2] row_mask:0xf bank_mask:0xf
  v_add_f32_dpp v60, v64, v64 quad_perm:[2,3,0,1] row_mask:0xf bank_mask:0xf
  v_add_f32_dpp v61, v65, v65 quad_perm:[2,3,0,1] row_mask:0xf bank_mask:0xf
  v_add_f32_dpp v62, v66, v66 quad_perm:[2,3,0,1] row_mask:0xf bank_mask:0xf
  v_add_f32_dpp v63, v67, v67 quad_perm:[2,3,0,1] row_mask:0xf bank_mask:0xf
  v_cvt_pk_bf16_f32 v64, v60, v61
  v_cvt_pk_bf16_f32 v65, v62, v63
  s_lshl_b32 s37, s27, 7
  v_lshlrev_b32 v51, 3, v51
  v_add_u32 v51, s37, v51
  s_lshl_b32 s37, s27, 2
  v_mov_b32 v50, s37
  s_mov_b32 exec_lo, 0x11111111
  s_mov_b32 exec_hi, 0x11111111
  ds_write_b64 v51, v[64:65] offset:1152
  ds_write_b32 v50, v3 offset:160
  s_mov_b64 exec, -1
  s_branch L_end
L_aux:
  s_setprio 3
  s_load_dwordx4 s[52:55], s[0:1], 80
  s_and_b32 s37, s7, 7
  s_lshl_b32 s37, s37, 2
  s_lshr_b32 s38, s7, 3
  s_add_u32 s37, s37, s38
  s_lshl_b32 s37, s37, 1
  s_lshr_b32 s38, s5, 1
  s_add_u32 s37, s37, s38
  s_and_b32 s38, s5, 1
  s_xor_b32 s38, s38, 1
  s_lshl_b32 s38, s38, 6
  s_add_u32 s63, s37, s38
  s_mul_i32 s62, s6, 20
  s_add_u32 s62, s62, s63
  s_and_b32 s37, s62, 1
  s_lshr_b32 s62, s62, 1
  s_lshl_b32 s62, s62, 14
  s_lshl_b32 s37, s37, 12
  s_add_u32 s62, s62, s37
  s_add_u32 s62, s62, 524288
  s_add_u32 s39, s62, 8192
  v_mov_b32 v30, 0
  s_waitcnt lgkmcnt(0)
  s_mov_b32 s28, s22
  s_and_b32 s29, s23, 0xffff
  s_mov_b32 s30, 268435456
  s_mov_b32 s31, 0x00020000
  s_mov_b32 s48, s52
  s_and_b32 s49, s53, 0xffff
  s_mov_b32 s50, 2560
  s_mov_b32 s51, 0x00020000
  s_waitcnt lgkmcnt(0)
  s_mul_i32 s25, s25, 0x9E3779B1
  s_add_u32 s25, s25, 0x7F4A7C15
  s_andn2_b32 s25, s25, 15
  s_or_b32 s25, s25, 8
  s_or_b32 s25, s25, s60
  v_mov_b32 v3, s25
  v_mov_b32 v17, 0
Lw_186:
  ds_read_b128 v[8:11], v17 offset:96
  ds_read_b128 v[12:15], v17 offset:112
  s_waitcnt lgkmcnt(0)
  v_xor_b32 v16, s25, v9
  v_xor_b32 v17, s25, v11
  v_or_b32 v16, v16, v17
  v_xor_b32 v17, s25, v13
  v_or_b32 v16, v16, v17
  v_xor_b32 v17, s25, v15
  v_or_b32 v16, v16, v17
  v_mov_b32 v17, 0
  v_cmp_ne_u32 vcc, 0, v16
  s_cmp_eq_u64 vcc, 0
  s_cbranch_scc1 Lwd_187
  s_sleep 1
  s_sub_u32 s26, s26, 1
  s_cbranch_scc0 Lw_186
  s_branch L_end
Lwd_187:
  v_mov_b32 v30, 0
  ds_read_b128 v[20:23], v30 offset:64
  ds_read_b128 v[24:27], v30 offset:80
  ds_read_b32 v31, v30 offset:148
  s_waitcnt lgkmcnt(0)
  v_readfirstlane_b32 s58, v31
  v_max_f32 v32, v20, v22
  v_max3_f32 v32, v32, v24, v26
  v_add_f32 v33, v8, v10
  v_add_f32 v34, v12, v14
  v_add_f32 v33, v33, v34
  v_mov_b32 v34, 0
  v_mov_b32 v35, 0
  v_perm_b32 v32, v32, v3, s40
  v_perm_b32 v33, v33, v3, s41
  v_perm_b32 v34, v34, v3, s42
  v_perm_b32 v35, v35, v3, s43
  s_lshl_b32 s36, s4, 7
  s_add_u32 s36, s36, 458752
  s_lshl_b32 s37, s5, 4
  s_add_u32 s37, s37, s36
  s_mov_b64 exec, 1
  s_cmp_lg_u32 s58, 0
  s_cbranch_scc1 L_ux1
  buffer_store_dwordx4 v[32:35], v30, s[28:31], s37 offen
  s_branch L_ux2
L_ux1:
  buffer_store_dwordx4 v[32:35], v30, s[28:31], s37 offen sc1
L_ux2:
  s_mov_b64 exec, -1
  v_and_b32 v36, 3, v0
  v_lshlrev_b32 v37, 4, v36
  buffer_load_dwordx4 v[48:51], v37, s[28:31], s36 offen sc1 nt
  s_sleep 10
  buffer_load_dwordx4 v[52:55], v37, s[28:31], s36 offen sc1 nt
  s_sleep 10
Lp_188:
  buffer_load_dwordx4 v[56:59], v37, s[28:31], s36 offen sc1 nt
  s_waitcnt vmcnt(2)
  v_perm_b32 v44, v49, v48, s44
  v_perm_b32 v45, v51, v50, s45
  v_or_b32 v44, v44, v45
  v_xor_b32 v44, s25, v44
  v_cmp_lt_u32 vcc, 7, v44
  s_cmp_eq_u64 vcc, 0
  s_cbranch_scc1 Lpf_190
  buffer_load_dwordx4 v[48:51], v37, s[28:31], s36 offen sc1 nt
  s_waitcnt vmcnt(2)
  v_perm_b32 v44, v53, v52, s44
  v_perm_b32 v45, v55, v54, s45
  v_or_b32 v44, v44, v45
  v_xor_b32 v44, s25, v44
  v_cmp_lt_u32 vcc, 7, v44
  s_cmp_eq_u64 vcc, 0
  s_cbranch_scc1 Lpf_191
  buffer_load_dwordx4 v[52:55], v37, s[28:31], s36 offen sc1 nt
  s_waitcnt vmcnt(2)
  v_perm_b32 v44, v57, v56, s44
  v_perm_b32 v45, v59, v58, s45
  v_or_b32 v44, v44, v45
  v_xor_b32 v44, s25, v44
  v_cmp_lt_u32 vcc, 7, v44
  s_cmp_eq_u64 vcc, 0
  s_cbranch_scc1 Lpf_192
  s_sub_u32 s26, s26, 1
  s_cbranch_scc0 Lp_188
  s_branch L_end
L_pad16:
  s_branch L_pad17
Lpf_190:
  v_mov_b32 v40, v48
  v_mov_b32 v41, v49
  v_mov_b32 v42, v50
  v_mov_b32 v43, v51
  s_branch Lpd_189
Lpf_191:
  v_mov_b32 v40, v52
  v_mov_b32 v41, v53
  v_mov_b32 v42, v54
  v_mov_b32 v43, v55
  s_branch Lpd_189
.p2align 12
L_pad17:
  s_branch L_pdone
Lpf_192:
  v_mov_b32 v40, v56
  v_mov_b32 v41, v57
  v_mov_b32 v42, v58
  v_mov_b32 v43, v59
Lpd_189:
  s_nop 1
  v_and_b32 v40, 0xffffff00, v40
  s_nop 1
  v_max_f32_dpp v44, v40, v40 quad_perm:[1,0,3,2] row_mask:0xf bank_mask:0xf
  s_nop 1
  v_max_f32_dpp v44, v44, v44 quad_perm:[2,3,0,1] row_mask:0xf bank_mask:0xf
  v_sub_f32 v40, v40, v44
  v_mul_f32 v40, 0x3fb8aa3b, v40
  v_exp_f32 v40, v40
  s_nop 0
  v_mul_f32 v41, v41, v40
  s_nop 1
  v_add_f32_dpp v44, v41, v41 quad_perm:[1,0,3,2] row_mask:0xf bank_mask:0xf
  s_nop 1
  v_add_f32_dpp v44, v44, v44 quad_perm:[2,3,0,1] row_mask:0xf bank_mask:0xf
  v_rcp_f32 v44, v44
  s_nop 0
  v_mul_f32 v40, v40, v44
  v_lshlrev_b32 v36, 2, v36
  s_mov_b64 exec, 15
  ds_write_b32 v36, v40 offset:128
  ds_write_b32 v30, v3 offset:144
  s_mov_b64 exec, -1
  s_mov_b32 s59, s63
  s_cmp_ge_u32 s59, 20
  s_cbranch_scc1 L_end
  s_mul_i32 s36, s6, 20
  s_add_u32 s36, s36, s59
  s_mul_i32 s38, s36, 64
  s_mul_i32 s36, s36, 4096
  s_add_u32 s36, s36, 524288
  s_lshl_b32 s32, s60, 10
  s_add_u32 s32, s32, 499712
  v_lshlrev_b32 v37, 4, v0
  buffer_load_dwordx4 v[60:63], v37, s[28:31], s32 offen sc1 nt
  s_waitcnt vmcnt(0)
  s_mov_b32 s37, 0
  s_mov_b32 s39, 0
  s_xor_b32 s33, s25, 16
  v_cmp_eq_u32 vcc, s25, v60
  s_bcnt1_i32_b64 s34, vcc
  s_add_u32 s37, s37, s34
  v_cmp_eq_u32 vcc, s33, v60
  s_bcnt1_i32_b64 s34, vcc
  s_add_u32 s39, s39, s34
  v_cmp_eq_u32 vcc, s25, v61
  s_bcnt1_i32_b64 s34, vcc
  s_add_u32 s37, s37, s34
  v_cmp_eq_u32 vcc, s33, v61
  s_bcnt1_i32_b64 s34, vcc
  s_add_u32 s39, s39, s34
  v_cmp_eq_u32 vcc, s25, v62
  s_bcnt1_i32_b64 s34, vcc
  s_add_u32 s37, s37, s34
  v_cmp_eq_u32 vcc, s33, v62
  s_bcnt1_i32_b64 s34, vcc
  s_add_u32 s39, s39, s34
  v_cmp_eq_u32 vcc, s25, v63
  s_bcnt1_i32_b64 s34, vcc
  s_add_u32 s37, s37, s34
  v_cmp_eq_u32 vcc, s33, v63
  s_bcnt1_i32_b64 s34, vcc
  s_add_u32 s39, s39, s34
  s_cmp_gt_u32 s39, s37
  s_cselect_b32 s37, 0, 8192
  s_add_u32 s62, s62, s37
  s_mov_b32 s36, s62
  v_lshlrev_b32 v37, 4, v0
  v_lshlrev_b32 v38, 3, v0
  v_mov_b32 v13, 0
Lw_193:
  ds_read_b128 v[8:11], v13 offset:176
  s_waitcnt lgkmcnt(0)
  v_xor_b32 v12, s25, v8
  v_xor_b32 v13, s25, v9
  v_or_b32 v12, v12, v13
  v_xor_b32 v13, s25, v10
  v_or_b32 v12, v12, v13
  v_mov_b32 v13, 0
  v_cmp_ne_u32 vcc, 0, v12
  s_cmp_eq_u64 vcc, 0
  s_cbranch_scc1 Lwd_194
  s_sleep 1
  s_sub_u32 s26, s26, 1
  s_cbranch_scc0 Lw_193
  s_branch L_end
Lwd_194:
L_fp:
  buffer_load_dwordx4 v[80:83], v37, s[28:31], s36 offen offset:0 sc1
  buffer_load_dwordx4 v[84:87], v37, s[28:31], s36 offen offset:1024 sc1
  buffer_load_dwordx4 v[88:91], v37, s[28:31], s36 offen offset:2048 sc1
  buffer_load_dwordx4 v[92:95], v37, s[28:31], s36 offen offset:3072 sc1
  s_waitcnt vmcnt(3)
  v_perm_b32 v44, v81, v80, s44
  v_perm_b32 v45, v83, v82, s45
  v_or_b32 v44, v44, v45
  v_xor_b32 v44, s25, v44
  v_mov_b32 v46, v44
  v_mov_b32 v40, v80
  v_mov_b32 v41, v81
  v_mov_b32 v42, v82
  v_mov_b32 v43, v83
  s_waitcnt vmcnt(2)
  v_perm_b32 v44, v85, v84, s44
  v_perm_b32 v45, v87, v86, s45
  v_or_b32 v44, v44, v45
  v_xor_b32 v44, s25, v44
  v_or_b32 v46, v46, v44
  v_add_f32 v40, v40, v84
  v_add_f32 v41, v41, v85
  v_add_f32 v42, v42, v86
  v_add_f32 v43, v43, v87
  s_waitcnt vmcnt(1)
  v_perm_b32 v44, v89, v88, s44
  v_perm_b32 v45, v91, v90, s45
  v_or_b32 v44, v44, v45
  v_xor_b32 v44, s25, v44
  v_or_b32 v46, v46, v44
  v_add_f32 v40, v40, v88
  v_add_f32 v41, v41, v89
  v_add_f32 v42, v42, v90
  v_add_f32 v43, v43, v91
  s_waitcnt vmcnt(0)
  v_perm_b32 v44, v93, v92, s44
  v_perm_b32 v45, v95, v94, s45
  v_or_b32 v44, v44, v45
  v_xor_b32 v44, s25, v44
  v_or_b32 v46, v46, v44
  v_add_f32 v40, v40, v92
  v_add_f32 v41, v41, v93
  v_add_f32 v42, v42, v94
  v_add_f32 v43, v43, v95
  v_cmp_lt_u32 vcc, 7, v46
  s_cmp_eq_u64 vcc, 0
  s_cbranch_scc1 L_fpd
  s_sub_u32 s26, s26, 1
  s_cbranch_scc0 L_fp
  s_branch L_end
L_fpd:
  v_add_f32_dpp v40, v40, v40 row_ror:8 row_mask:0xf bank_mask:0xf
  v_add_f32_dpp v41, v41, v41 row_ror:8 row_mask:0xf bank_mask:0xf
  v_add_f32_dpp v42, v42, v42 row_ror:8 row_mask:0xf bank_mask:0xf
  v_add_f32_dpp v43, v43, v43 row_ror:8 row_mask:0xf bank_mask:0xf
  v_mov_b32 v44, v40
  v_mov_b32 v45, v41
  v_mov_b32 v46, v42
  v_mov_b32 v47, v43
  s_nop 1
  v_permlane16_swap_b32 v40, v44
  v_permlane16_swap_b32 v41, v45
  v_permlane16_swap_b32 v42, v46
  v_permlane16_swap_b32 v43, v47
  s_nop 1
  v_add_f32 v40, v40, v44
  v_add_f32 v41, v41, v45
  v_add_f32 v42, v42, v46
  v_add_f32 v43, v43, v47
  v_mov_b32 v44, v40
  v_mov_b32 v45, v41
  v_mov_b32 v46, v42
  v_mov_b32 v47, v43
  s_nop 1
  v_permlane32_swap_b32 v40, v44
  v_permlane32_swap_b32 v41, v45
  v_permlane32_swap_b32 v42, v46
  v_permlane32_swap_b32 v43, v47
  s_nop 1
  v_add_f32 v40, v40, v44
  v_add_f32 v41, v41, v45
  v_add_f32 v42, v42, v46
  v_add_f32 v43, v43, v47
  v_cvt_pk_bf16_f32 v44, v40, v41
  v_cvt_pk_bf16_f32 v45, v42, v43
  s_mov_b64 exec, 255
  buffer_store_dwordx2 v[44:45], v38, s[48:51], s38 offen
  s_cmp_lg_u32 s59, 0
  s_cbranch_scc1 L_aux2
  s_mov_b64 exec, 1
  buffer_store_dword v3, v30, s[28:31], s9 offen
L_aux2:
  s_mov_b64 exec, -1
L_end:
L_done:
  s_endpgm
.section .rodata,"a"
.p2align 6
.amdhsa_kernel concat_heads__sliding_block_cached__sliding_block_cached__decode_kernel
  .amdhsa_next_free_vgpr 168
  .amdhsa_next_free_sgpr 102
  .amdhsa_accum_offset 168
  .amdhsa_group_segment_fixed_size 0
  .amdhsa_kernarg_size 104
  .amdhsa_user_sgpr_count 2
  .amdhsa_user_sgpr_kernarg_segment_ptr 1
  .amdhsa_system_sgpr_workgroup_id_x 1
.end_amdhsa_kernel
```
